```python
import torch

def _softmax(x, axis=-1):
    return torch.softmax(x, dim=axis)
def _gelu(x):
    return torch.nn.functional.gelu(x, approximate="tanh")
def _silu(x):
    return torch.nn.functional.silu(x)
def _sigmoid(x):
    return torch.sigmoid(x)
def _layernorm(x, axis=-1, eps=1e-5):
    m = x.mean(dim=axis, keepdim=True)
    v = x.var(dim=axis, keepdim=True, unbiased=False)
    return (x - m) / torch.sqrt(v + eps)
def _scatter_add(tgt, idx, src, axis=0):
    return tgt.clone().index_add_(axis, idx, src)
def _segment_sum(src, seg, n):
    out = torch.zeros((n,) + src.shape[1:], dtype=src.dtype)
    return out.index_add_(0, seg, src)
def _pad(x, pw):
    flat = tuple(v for pair in reversed(pw) for v in pair)
    return torch.nn.functional.pad(x, flat)

kernel_name = 'parallel_sum__ssm_conv_h3__geglu_ffn__prompt'

def setup_inputs():

    _w = (lambda a: (lambda t: t.to(torch.bfloat16) if t.is_floating_point() else t)(torch.as_tensor(a)))
    def _A_setup():
        B, S, D = 1, 2048, 512
        ks = 4
        return {
            "q": _w((lambda *s: torch.randn(*s, dtype=torch.bfloat16) * 0.05)(B, S, D)),
            "k": _w((lambda *s: torch.randn(*s, dtype=torch.bfloat16) * 0.8)(B, S, D)),
            "v": _w((lambda *s: torch.randn(*s, dtype=torch.bfloat16) * 0.8)(B, S, D)),
            "shift_k": _w((lambda *s: torch.randn(*s, dtype=torch.bfloat16) * 0.8)(D, ks) * 0.5),
            "ssm_k": _w((lambda *s: torch.randn(*s, dtype=torch.bfloat16) * 0.8)(D, S) * (1.0 / S ** 0.5)),
            "ssm_D": _w((lambda *s: torch.randn(*s, dtype=torch.bfloat16) * 0.8)(D)),
        }
    _A_in = _A_setup()

    def _B_setup():
        B, S, D, F = 1, 2048, 512, 1792
        return {
            "x": _w((lambda *s: torch.randn(*s, dtype=torch.bfloat16) * 0.05)(B, S, D)),
            "w_gate": _w((lambda *s: torch.randn(*s, dtype=torch.bfloat16) * 0.05)(D, F)),
            "w_up": _w((lambda *s: torch.randn(*s, dtype=torch.bfloat16) * 0.05)(D, F)),
            "w_down": _w((lambda *s: torch.randn(*s, dtype=torch.bfloat16) * 0.05)(F, D)),
        }
    _B_in = _B_setup()

    return {
        "A_q": _A_in["q"],
        "A_k": _A_in["k"],
        "A_v": _A_in["v"],
        "A_shift_k": _A_in["shift_k"],
        "A_ssm_k": _A_in["ssm_k"],
        "A_ssm_D": _A_in["ssm_D"],
        "B_x": _B_in["x"],
        "B_w_gate": _B_in["w_gate"],
        "B_w_up": _B_in["w_up"],
        "B_w_down": _B_in["w_down"],
    }

def reference(A_q, A_k, A_v, A_shift_k, A_ssm_k, A_ssm_D, B_x, B_w_gate, B_w_up, B_w_down):
    def _A_ref(q, k, v, shift_k, ssm_k, ssm_D):
        B, S, D = q.shape
        ks = shift_k.shape[-1]
        k_pad = _pad(k, ((0, 0), (ks - 1, 0), (0, 0)))
        k_shift = torch.zeros_like(k)
        for t in range(ks):
            k_shift = k_shift + k_pad[:, t:t + S, :] * shift_k[:, ks - 1 - t][None, None, :]
        kv = k_shift * v
        L = 2 * S
        kv_pad = _pad(kv, ((0, 0), (0, S), (0, 0)))
        kf_pad = _pad(ssm_k, ((0, 0), (0, S)))
        kv_f = (lambda x, axes=(-2,-1): torch.fft.rfft2(x.float(), dim=axes))(kv_pad[:, None, :, :], axes=(1, 2))
        kf_f = (lambda x, axes=(-2,-1): torch.fft.rfft2(x.float(), dim=axes))(kf_pad[:, None, :], axes=(1, 2))
        kf_f = (lambda x, *d: x.permute(*d))(kf_f, 1, 2, 0)
        y_f = kv_f * kf_f[None, :, :, :]
        y = (lambda x, s, axes=(-2,-1): torch.fft.irfft2(x, s=s, dim=axes).to(torch.bfloat16))(y_f, (1, L), axes=(1, 2))[:, 0, :S, :]
        y = y + kv * ssm_D[None, None, :]
        return q * y

    def _B_ref(x, w_gate, w_up, w_down):
        return (_gelu(x @ w_gate) * (x @ w_up)) @ w_down

    x = A_q
    xn = _layernorm(x, axis=-1)
    return x + _A_ref(xn, A_k, A_v, A_shift_k, A_ssm_k, A_ssm_D) + _B_ref(xn, B_w_gate, B_w_up, B_w_down)
```

```asm
; @launch grid=(256,1,1) block=(512,1,1) lds=163840
.amdgcn_target "amdgcn-amd-amdhsa--gfx950"
.text
.globl parallel_sum__ssm_conv_h3__geglu_ffn__prompt_kernel
.p2align 8
.type parallel_sum__ssm_conv_h3__geglu_ffn__prompt_kernel,@function
parallel_sum__ssm_conv_h3__geglu_ffn__prompt_kernel:
    s_cmp_ge_u32 s2, 256
    s_cbranch_scc1 L_end
    s_load_dwordx16 s[16:31], s[0:1], 0
    s_load_dwordx8 s[32:39], s[0:1], 64
    s_load_dwordx2 s[40:41], s[0:1], 96
    v_lshrrev_b32 v1, 6, v0
    v_and_b32 v2, 63, v0
    s_and_b32 s4, s2, 7
    v_readfirstlane_b32 s3, v1
    s_lshr_b32 s5, s2, 3
    v_and_b32 v3, 15, v2
    v_lshrrev_b32 v1, 4, v2
    s_waitcnt lgkmcnt(0)
    s_mov_b32 s44, s40
    s_and_b32 s45, s41, 0xffff
    s_mov_b32 s46, 17825792
    s_mov_b32 s47, 0x20000
    s_mov_b32 s64, s38
    s_and_b32 s65, s39, 0xffff
    s_mov_b32 s66, 256
    s_mov_b32 s67, 0x20000
    s_lshl_b32 s76, s4, 2
    s_and_b32 s77, s5, 3
    s_add_u32 s76, s76, s77
    s_lshr_b32 s77, s5, 2
    s_lshl_b32 s68, s3, 2
    s_add_u32 s68, s68, 162816
    v_mov_b32 v4, s68
    v_mov_b32 v5, 0
    ds_write_b32 v4, v5
    s_cmp_lg_u32 s2, 0
    s_cbranch_scc1 L_notag
    s_cmp_lg_u32 s3, 7
    s_cbranch_scc1 L_notag
    s_memrealtime s[68:69]
    s_waitcnt lgkmcnt(0)
    s_or_b32 s69, s69, 0x80000000
    v_mov_b32 v4, s68
    v_mov_b32 v5, s69
    s_mov_b64 exec, 1
    buffer_store_dwordx2 v[4:5], off, s[64:67], 0 sc1
    s_mov_b64 exec, -1
L_notag:
    s_cmp_lt_u32 s5, 4
    s_cbranch_scc1 L_prep
    s_sub_u32 s68, s5, 4
    s_and_b32 s8, s4, 3
    s_lshl_b32 s8, s8, 2
    s_and_b32 s69, s68, 3
    s_add_u32 s8, s8, s69
    s_lshr_b32 s9, s4, 2
    s_mul_i32 s9, s9, 7
    s_lshr_b32 s69, s68, 2
    s_add_u32 s9, s9, s69
    s_cmp_lt_u32 s3, 4
    s_cbranch_scc1 L_g1
    s_sub_u32 s10, s3, 4
    s_cmp_lt_u32 s10, 2
    s_cselect_b32 s68, s30, s32
    s_cselect_b32 s69, s31, s33
    s_mov_b32 s48, s68
    s_and_b32 s49, s69, 0xffff
    s_mov_b32 s50, 1835008
    s_mov_b32 s51, 0x20000
    s_mov_b32 s52, s16
    s_and_b32 s53, s17, 0xffff
    s_mov_b32 s54, 2097152
    s_mov_b32 s55, 0x20000
    s_and_b32 s11, s10, 1
    s_lshl_b32 s11, s11, 4
    v_add_u32 v4, s11, v1
    v_mul_u32_u24 v4, 3584, v4
    v_lshrrev_b32 v5, 1, v3
    v_xor_b32 v5, v5, v1
    v_lshl_add_u32 v4, v5, 5, v4
    v_and_b32 v5, 1, v3
    v_lshl_add_u32 v4, v5, 4, v4
    v_xor_b32 v5, 128, v4
    v_lshrrev_b32 v6, 3, v2
    v_and_b32 v7, 7, v2
    v_xor_b32 v7, v7, v6
    s_lshl_b32 s68, s10, 5
    v_add_u32 v6, s68, v6
    v_lshlrev_b32 v6, 10, v6
    v_lshl_add_u32 v6, v7, 4, v6
    s_lshl_b32 s12, s9, 8
    s_lshl_b32 s13, s8, 17
    s_lshl_b32 s14, s10, 12
    s_add_u32 s15, s14, 98304
    s_sub_u32 s68, s5, 4
    s_and_b32 s69, s68, 3
    s_lshl_b32 s69, s69, 1
    s_lshr_b32 s68, s68, 2
    s_add_u32 s68, s68, s69
    s_and_b32 s68, s68, 0
    s_add_u32 s80, s12, 1835008
    s_add_u32 s81, s13, 1024
    s_mul_i32 s69, s68, 229376
    s_add_u32 s12, s12, s69
    s_lshl_b32 s69, s68, 7
    s_add_u32 s13, s13, s69
    s_add_u32 m0, s15, 0
    s_add_u32 s68, s13, 0
    buffer_load_dwordx4 v6, s[52:55], s68 offen  lds
    s_add_u32 m0, s15, 1024
    s_add_u32 s68, s13, 8192
    buffer_load_dwordx4 v6, s[52:55], s68 offen  lds
    s_add_u32 m0, s15, 2048
    s_add_u32 s68, s13, 16384
    buffer_load_dwordx4 v6, s[52:55], s68 offen  lds
    s_add_u32 m0, s15, 3072
    s_add_u32 s68, s13, 24576
    buffer_load_dwordx4 v6, s[52:55], s68 offen  lds
    s_add_u32 s13, s13, 128
    s_cmp_eq_u32 s13, s81
    s_cselect_b32 s68, 1024, 0
    s_sub_u32 s13, s13, s68
    s_add_u32 m0, s14, 0
    s_add_u32 s68, s12, 0
    buffer_load_dwordx4 v4, s[48:51], s68 offen  lds
    s_add_u32 m0, s14, 1024
    s_add_u32 s68, s12, 14336
    buffer_load_dwordx4 v4, s[48:51], s68 offen  lds
    s_add_u32 m0, s14, 2048
    s_add_u32 s68, s12, 28672
    buffer_load_dwordx4 v5, s[48:51], s68 offen  lds
    s_add_u32 m0, s14, 3072
    s_add_u32 s68, s12, 43008
    buffer_load_dwordx4 v5, s[48:51], s68 offen  lds
    s_add_u32 m0, s14, 16384
    s_add_u32 s68, s12, 114688
    buffer_load_dwordx4 v4, s[48:51], s68 offen  lds
    s_add_u32 m0, s14, 17408
    s_add_u32 s68, s12, 129024
    buffer_load_dwordx4 v4, s[48:51], s68 offen  lds
    s_add_u32 m0, s14, 18432
    s_add_u32 s68, s12, 143360
    buffer_load_dwordx4 v5, s[48:51], s68 offen  lds
    s_add_u32 m0, s14, 19456
    s_add_u32 s68, s12, 157696
    buffer_load_dwordx4 v5, s[48:51], s68 offen  lds
    s_add_u32 s12, s12, 229376
    s_cmp_eq_u32 s12, s80
    s_cselect_b32 s68, 1835008, 0
    s_sub_u32 s12, s12, s68
    s_add_u32 m0, s15, 16384
    s_add_u32 s68, s13, 0
    buffer_load_dwordx4 v6, s[52:55], s68 offen  lds
    s_add_u32 m0, s15, 17408
    s_add_u32 s68, s13, 8192
    buffer_load_dwordx4 v6, s[52:55], s68 offen  lds
    s_add_u32 m0, s15, 18432
    s_add_u32 s68, s13, 16384
    buffer_load_dwordx4 v6, s[52:55], s68 offen  lds
    s_add_u32 m0, s15, 19456
    s_add_u32 s68, s13, 24576
    buffer_load_dwordx4 v6, s[52:55], s68 offen  lds
    s_add_u32 s13, s13, 128
    s_cmp_eq_u32 s13, s81
    s_cselect_b32 s68, 1024, 0
    s_sub_u32 s13, s13, s68
    s_add_u32 m0, s14, 32768
    s_add_u32 s68, s12, 0
    buffer_load_dwordx4 v4, s[48:51], s68 offen  lds
    s_add_u32 m0, s14, 33792
    s_add_u32 s68, s12, 14336
    buffer_load_dwordx4 v4, s[48:51], s68 offen  lds
    s_add_u32 m0, s14, 34816
    s_add_u32 s68, s12, 28672
    buffer_load_dwordx4 v5, s[48:51], s68 offen  lds
    s_add_u32 m0, s14, 35840
    s_add_u32 s68, s12, 43008
    buffer_load_dwordx4 v5, s[48:51], s68 offen  lds
    s_add_u32 m0, s14, 49152
    s_add_u32 s68, s12, 114688
    buffer_load_dwordx4 v4, s[48:51], s68 offen  lds
    s_add_u32 m0, s14, 50176
    s_add_u32 s68, s12, 129024
    buffer_load_dwordx4 v4, s[48:51], s68 offen  lds
    s_add_u32 m0, s14, 51200
    s_add_u32 s68, s12, 143360
    buffer_load_dwordx4 v5, s[48:51], s68 offen  lds
    s_add_u32 m0, s14, 52224
    s_add_u32 s68, s12, 157696
    buffer_load_dwordx4 v5, s[48:51], s68 offen  lds
    s_add_u32 s12, s12, 229376
    s_cmp_eq_u32 s12, s80
    s_cselect_b32 s68, 1835008, 0
    s_sub_u32 s12, s12, s68
    s_add_u32 m0, s15, 32768
    s_add_u32 s68, s13, 0
    buffer_load_dwordx4 v6, s[52:55], s68 offen  lds
    s_add_u32 m0, s15, 33792
    s_add_u32 s68, s13, 8192
    buffer_load_dwordx4 v6, s[52:55], s68 offen  lds
    s_add_u32 m0, s15, 34816
    s_add_u32 s68, s13, 16384
    buffer_load_dwordx4 v6, s[52:55], s68 offen  lds
    s_add_u32 m0, s15, 35840
    s_add_u32 s68, s13, 24576
    buffer_load_dwordx4 v6, s[52:55], s68 offen  lds
    s_add_u32 s13, s13, 128
    s_cmp_eq_u32 s13, s81
    s_cselect_b32 s68, 1024, 0
    s_sub_u32 s13, s13, s68
    s_add_u32 m0, s14, 65536
    s_add_u32 s68, s12, 0
    buffer_load_dwordx4 v4, s[48:51], s68 offen  lds
    s_add_u32 m0, s14, 66560
    s_add_u32 s68, s12, 14336
    buffer_load_dwordx4 v4, s[48:51], s68 offen  lds
    s_add_u32 m0, s14, 67584
    s_add_u32 s68, s12, 28672
    buffer_load_dwordx4 v5, s[48:51], s68 offen  lds
    s_add_u32 m0, s14, 68608
    s_add_u32 s68, s12, 43008
    buffer_load_dwordx4 v5, s[48:51], s68 offen  lds
    s_add_u32 m0, s14, 81920
    s_add_u32 s68, s12, 114688
    buffer_load_dwordx4 v4, s[48:51], s68 offen  lds
    s_add_u32 m0, s14, 82944
    s_add_u32 s68, s12, 129024
    buffer_load_dwordx4 v4, s[48:51], s68 offen  lds
    s_add_u32 m0, s14, 83968
    s_add_u32 s68, s12, 143360
    buffer_load_dwordx4 v5, s[48:51], s68 offen  lds
    s_add_u32 m0, s14, 84992
    s_add_u32 s68, s12, 157696
    buffer_load_dwordx4 v5, s[48:51], s68 offen  lds
    s_add_u32 s12, s12, 229376
    s_cmp_eq_u32 s12, s80
    s_cselect_b32 s68, 1835008, 0
    s_sub_u32 s12, s12, s68
    s_and_b32 s68, s8, 3
    s_lshl_b32 s68, s68, 1
    s_and_b32 s69, s10, 1
    s_add_u32 s68, s68, s69
    s_mul_i32 s68, s68, 114688
    s_lshl_b32 s69, s9, 8
    s_add_u32 s68, s68, s69
    s_add_u32 s68, s68, 917504
    v_lshrrev_b32 v8, 1, v2
    v_mul_u32_u24 v8, 3584, v8
    v_and_b32 v9, 1, v2
    v_lshl_add_u32 v8, v9, 7, v8
    buffer_load_dword v113, v8, s[48:51], s68 offen
    s_sub_u32 s68, s5, 4
    s_lshr_b32 s68, s68, 2
    s_add_u32 s68, s68, 3
    s_min_u32 s68, s68, 7
    s_lshl_b32 s68, s68, 7
    s_lshl_b32 s69, s8, 17
    s_add_u32 s68, s68, s69
    s_lshl_b32 s69, s10, 15
    s_add_u32 s68, s68, s69
    v_and_b32 v8, 31, v2
    v_lshlrev_b32 v8, 10, v8
    buffer_load_dword v113, v8, s[52:55], s68 offen
    s_mov_b32 s92, s34
    s_and_b32 s93, s35, 0xffff
    s_mov_b32 s94, 1835008
    s_mov_b32 s95, 0x20000
    v_lshrrev_b32 v24, 3, v2
    v_bfe_u32 v25, v2, 1, 2
    v_xor_b32 v25, v25, v1
    v_lshlrev_b32 v24, 10, v24
    v_lshl_add_u32 v24, v25, 5, v24
    v_and_b32 v25, 1, v2
    v_lshl_add_u32 v24, v25, 4, v24
    s_and_b32 s83, s3, 3
    s_mul_i32 s82, s83, 458752
    s_lshl_b32 s68, s77, 7
    s_add_u32 s82, s82, s68
    s_lshl_b32 s83, s83, 12
    s_waitcnt vmcnt(30)
    s_barrier
    s_waitcnt vmcnt(26)
    s_barrier
    s_add_u32 m0, s14, 0
    s_add_u32 s68, s12, 0
    buffer_load_dwordx4 v4, s[48:51], s68 offen  lds
    s_add_u32 m0, s14, 1024
    s_add_u32 s68, s12, 14336
    buffer_load_dwordx4 v4, s[48:51], s68 offen  lds
    s_add_u32 m0, s14, 2048
    s_add_u32 s68, s12, 28672
    buffer_load_dwordx4 v5, s[48:51], s68 offen  lds
    s_add_u32 m0, s14, 3072
    s_add_u32 s68, s12, 43008
    buffer_load_dwordx4 v5, s[48:51], s68 offen  lds
    s_waitcnt vmcnt(22)
    s_barrier
    s_add_u32 m0, s14, 16384
    s_add_u32 s68, s12, 114688
    buffer_load_dwordx4 v4, s[48:51], s68 offen  lds
    s_add_u32 m0, s14, 17408
    s_add_u32 s68, s12, 129024
    buffer_load_dwordx4 v4, s[48:51], s68 offen  lds
    s_add_u32 m0, s14, 18432
    s_add_u32 s68, s12, 143360
    buffer_load_dwordx4 v5, s[48:51], s68 offen  lds
    s_add_u32 m0, s14, 19456
    s_add_u32 s68, s12, 157696
    buffer_load_dwordx4 v5, s[48:51], s68 offen  lds
    s_add_u32 s12, s12, 229376
    s_cmp_eq_u32 s12, s80
    s_cselect_b32 s68, 1835008, 0
    s_sub_u32 s12, s12, s68
    s_add_u32 m0, s15, 0
    s_add_u32 s68, s13, 0
    buffer_load_dwordx4 v6, s[52:55], s68 offen  lds
    s_add_u32 m0, s15, 1024
    s_add_u32 s68, s13, 8192
    buffer_load_dwordx4 v6, s[52:55], s68 offen  lds
    s_add_u32 m0, s15, 2048
    s_add_u32 s68, s13, 16384
    buffer_load_dwordx4 v6, s[52:55], s68 offen  lds
    s_add_u32 m0, s15, 3072
    s_add_u32 s68, s13, 24576
    buffer_load_dwordx4 v6, s[52:55], s68 offen  lds
    s_add_u32 s13, s13, 128
    s_cmp_eq_u32 s13, s81
    s_cselect_b32 s68, 1024, 0
    s_sub_u32 s13, s13, s68
    s_waitcnt vmcnt(26)
    s_barrier
    s_add_u32 m0, s14, 32768
    s_add_u32 s68, s12, 0
    buffer_load_dwordx4 v4, s[48:51], s68 offen  lds
    s_add_u32 m0, s14, 33792
    s_add_u32 s68, s12, 14336
    buffer_load_dwordx4 v4, s[48:51], s68 offen  lds
    s_add_u32 m0, s14, 34816
    s_add_u32 s68, s12, 28672
    buffer_load_dwordx4 v5, s[48:51], s68 offen  lds
    s_add_u32 m0, s14, 35840
    s_add_u32 s68, s12, 43008
    buffer_load_dwordx4 v5, s[48:51], s68 offen  lds
    s_waitcnt vmcnt(22)
    s_barrier
    s_add_u32 m0, s14, 49152
    s_add_u32 s68, s12, 114688
    buffer_load_dwordx4 v4, s[48:51], s68 offen  lds
    s_add_u32 m0, s14, 50176
    s_add_u32 s68, s12, 129024
    buffer_load_dwordx4 v4, s[48:51], s68 offen  lds
    s_add_u32 m0, s14, 51200
    s_add_u32 s68, s12, 143360
    buffer_load_dwordx4 v5, s[48:51], s68 offen  lds
    s_add_u32 m0, s14, 52224
    s_add_u32 s68, s12, 157696
    buffer_load_dwordx4 v5, s[48:51], s68 offen  lds
    s_add_u32 s12, s12, 229376
    s_cmp_eq_u32 s12, s80
    s_cselect_b32 s68, 1835008, 0
    s_sub_u32 s12, s12, s68
    s_add_u32 m0, s15, 16384
    s_add_u32 s68, s13, 0
    buffer_load_dwordx4 v6, s[52:55], s68 offen  lds
    s_add_u32 m0, s15, 17408
    s_add_u32 s68, s13, 8192
    buffer_load_dwordx4 v6, s[52:55], s68 offen  lds
    s_add_u32 m0, s15, 18432
    s_add_u32 s68, s13, 16384
    buffer_load_dwordx4 v6, s[52:55], s68 offen  lds
    s_add_u32 m0, s15, 19456
    s_add_u32 s68, s13, 24576
    buffer_load_dwordx4 v6, s[52:55], s68 offen  lds
    s_add_u32 s13, s13, 128
    s_cmp_eq_u32 s13, s81
    s_cselect_b32 s68, 1024, 0
    s_sub_u32 s13, s13, s68
    s_waitcnt vmcnt(26)
    s_barrier
    buffer_load_dwordx2 v[28:29], off, s[64:67], 0
    s_add_u32 m0, s14, 65536
    s_add_u32 s68, s12, 0
    buffer_load_dwordx4 v4, s[48:51], s68 offen  lds
    s_add_u32 m0, s14, 66560
    s_add_u32 s68, s12, 14336
    buffer_load_dwordx4 v4, s[48:51], s68 offen  lds
    s_add_u32 m0, s14, 67584
    s_add_u32 s68, s12, 28672
    buffer_load_dwordx4 v5, s[48:51], s68 offen  lds
    s_add_u32 m0, s14, 68608
    s_add_u32 s68, s12, 43008
    buffer_load_dwordx4 v5, s[48:51], s68 offen  lds
    s_waitcnt vmcnt(17)
    s_barrier
    s_add_u32 m0, s14, 81920
    s_add_u32 s68, s12, 114688
    buffer_load_dwordx4 v4, s[48:51], s68 offen  lds
    s_add_u32 m0, s14, 82944
    s_add_u32 s68, s12, 129024
    buffer_load_dwordx4 v4, s[48:51], s68 offen  lds
    s_add_u32 m0, s14, 83968
    s_add_u32 s68, s12, 143360
    buffer_load_dwordx4 v5, s[48:51], s68 offen  lds
    s_add_u32 m0, s14, 84992
    s_add_u32 s68, s12, 157696
    buffer_load_dwordx4 v5, s[48:51], s68 offen  lds
    s_add_u32 s12, s12, 229376
    s_cmp_eq_u32 s12, s80
    s_cselect_b32 s68, 1835008, 0
    s_sub_u32 s12, s12, s68
    s_add_u32 m0, s15, 32768
    s_add_u32 s68, s13, 0
    buffer_load_dwordx4 v6, s[52:55], s68 offen  lds
    s_add_u32 m0, s15, 33792
    s_add_u32 s68, s13, 8192
    buffer_load_dwordx4 v6, s[52:55], s68 offen  lds
    s_add_u32 m0, s15, 34816
    s_add_u32 s68, s13, 16384
    buffer_load_dwordx4 v6, s[52:55], s68 offen  lds
    s_add_u32 m0, s15, 35840
    s_add_u32 s68, s13, 24576
    buffer_load_dwordx4 v6, s[52:55], s68 offen  lds
    s_add_u32 s13, s13, 128
    s_cmp_eq_u32 s13, s81
    s_cselect_b32 s68, 1024, 0
    s_sub_u32 s13, s13, s68
    s_barrier
    s_add_u32 m0, s14, 0
    s_add_u32 s68, s12, 0
    buffer_load_dwordx4 v4, s[48:51], s68 offen  lds
    s_add_u32 m0, s14, 1024
    s_add_u32 s68, s12, 14336
    buffer_load_dwordx4 v4, s[48:51], s68 offen  lds
    s_add_u32 m0, s14, 2048
    s_add_u32 s68, s12, 28672
    buffer_load_dwordx4 v5, s[48:51], s68 offen  lds
    s_add_u32 m0, s14, 3072
    s_add_u32 s68, s12, 43008
    buffer_load_dwordx4 v5, s[48:51], s68 offen  lds
    s_waitcnt vmcnt(17)
    s_barrier
    s_add_u32 m0, s14, 16384
    s_add_u32 s68, s12, 114688
    buffer_load_dwordx4 v4, s[48:51], s68 offen  lds
    s_add_u32 m0, s14, 17408
    s_add_u32 s68, s12, 129024
    buffer_load_dwordx4 v4, s[48:51], s68 offen  lds
    s_add_u32 m0, s14, 18432
    s_add_u32 s68, s12, 143360
    buffer_load_dwordx4 v5, s[48:51], s68 offen  lds
    s_add_u32 m0, s14, 19456
    s_add_u32 s68, s12, 157696
    buffer_load_dwordx4 v5, s[48:51], s68 offen  lds
    s_add_u32 s12, s12, 229376
    s_cmp_eq_u32 s12, s80
    s_cselect_b32 s68, 1835008, 0
    s_sub_u32 s12, s12, s68
    s_add_u32 m0, s15, 0
    s_add_u32 s68, s13, 0
    buffer_load_dwordx4 v6, s[52:55], s68 offen  lds
    s_add_u32 m0, s15, 1024
    s_add_u32 s68, s13, 8192
    buffer_load_dwordx4 v6, s[52:55], s68 offen  lds
    s_add_u32 m0, s15, 2048
    s_add_u32 s68, s13, 16384
    buffer_load_dwordx4 v6, s[52:55], s68 offen  lds
    s_add_u32 m0, s15, 3072
    s_add_u32 s68, s13, 24576
    buffer_load_dwordx4 v6, s[52:55], s68 offen  lds
    s_add_u32 s13, s13, 128
    s_cmp_eq_u32 s13, s81
    s_cselect_b32 s68, 1024, 0
    s_sub_u32 s13, s13, s68
    s_barrier
    s_add_u32 m0, s14, 32768
    s_add_u32 s68, s12, 0
    buffer_load_dwordx4 v4, s[48:51], s68 offen  lds
    s_add_u32 m0, s14, 33792
    s_add_u32 s68, s12, 14336
    buffer_load_dwordx4 v4, s[48:51], s68 offen  lds
    s_add_u32 m0, s14, 34816
    s_add_u32 s68, s12, 28672
    buffer_load_dwordx4 v5, s[48:51], s68 offen  lds
    s_add_u32 m0, s14, 35840
    s_add_u32 s68, s12, 43008
    buffer_load_dwordx4 v5, s[48:51], s68 offen  lds
    s_waitcnt vmcnt(16)
    s_barrier
    s_mov_b32 s56, s24
    s_and_b32 s57, s25, 0xffff
    s_mov_b32 s58, 2097152
    s_mov_b32 s59, 0x20000
    s_mov_b32 s60, s26
    s_and_b32 s61, s27, 0xffff
    s_mov_b32 s62, 1024
    s_mov_b32 s63, 0x20000
    s_lshl_b32 s43, s4, 5
    s_add_u32 s43, s43, s5
    s_lshl_b32 s43, s43, 1
    s_bfe_u32 s68, s3, 0x10001
    s_add_u32 s43, s43, s68
    s_and_b32 s90, s3, 1
    s_lshl_b32 s68, s43, 12
    s_lshl_b32 s69, s90, 11
    s_add_u32 s68, s68, s69
    s_lshl_b32 s69, s43, 1
    v_lshlrev_b32 v9, 4, v2
    buffer_load_dwordx4 v[64:67], v9, s[56:59], s68 offen offset:0
    buffer_load_dwordx4 v[68:71], v9, s[56:59], s68 offen offset:4
    buffer_load_dwordx4 v[72:75], v9, s[56:59], s68 offen offset:8
    buffer_load_dwordx4 v[76:79], v9, s[56:59], s68 offen offset:1024
    buffer_load_dwordx4 v[80:83], v9, s[56:59], s68 offen offset:1028
    buffer_load_dwordx4 v[84:87], v9, s[56:59], s68 offen offset:1032
    buffer_load_ushort v112, off, s[60:63], s69
    s_add_u32 m0, s14, 49152
    s_add_u32 s68, s12, 114688
    buffer_load_dwordx4 v4, s[48:51], s68 offen  lds
    s_add_u32 m0, s14, 50176
    s_add_u32 s68, s12, 129024
    buffer_load_dwordx4 v4, s[48:51], s68 offen  lds
    s_add_u32 m0, s14, 51200
    s_add_u32 s68, s12, 143360
    buffer_load_dwordx4 v5, s[48:51], s68 offen  lds
    s_add_u32 m0, s14, 52224
    s_add_u32 s68, s12, 157696
    buffer_load_dwordx4 v5, s[48:51], s68 offen  lds
    s_add_u32 s12, s12, 229376
    s_cmp_eq_u32 s12, s80
    s_cselect_b32 s68, 1835008, 0
    s_sub_u32 s12, s12, s68
    s_add_u32 m0, s15, 16384
    s_add_u32 s68, s13, 0
    buffer_load_dwordx4 v6, s[52:55], s68 offen  lds
    s_add_u32 m0, s15, 17408
    s_add_u32 s68, s13, 8192
    buffer_load_dwordx4 v6, s[52:55], s68 offen  lds
    s_add_u32 m0, s15, 18432
    s_add_u32 s68, s13, 16384
    buffer_load_dwordx4 v6, s[52:55], s68 offen  lds
    s_add_u32 m0, s15, 19456
    s_add_u32 s68, s13, 24576
    buffer_load_dwordx4 v6, s[52:55], s68 offen  lds
    s_add_u32 s13, s13, 128
    s_cmp_eq_u32 s13, s81
    s_cselect_b32 s68, 1024, 0
    s_sub_u32 s13, s13, s68
    s_mul_i32 s68, s10, 458752
    s_mul_i32 s69, s5, 8192
    s_add_u32 s68, s68, s69
    s_add_u32 s68, s68, 4294934528
    v_lshlrev_b32 v8, 7, v2
    buffer_load_dword v113, v8, s[92:95], s68 offen
    s_mul_i32 s68, s10, 458752
    s_mul_i32 s69, s5, 8192
    s_add_u32 s68, s68, s69
    s_add_u32 s68, s68, 196608
    v_lshlrev_b32 v8, 7, v2
    buffer_load_dword v113, v8, s[92:95], s68 offen
    s_barrier
    s_waitcnt vmcnt(21)
    s_barrier
    s_barrier
    s_waitcnt vmcnt(2)
    s_barrier
    s_mov_b32 s68, 200000
tag_1:
    v_readfirstlane_b32 s6, v28
    v_readfirstlane_b32 s7, v29
    s_cmp_lg_u32 s7, 0
    s_cbranch_scc1 tagd_2
    s_sleep 2
    buffer_load_dwordx2 v[28:29], off, s[64:67], 0 sc1
    s_sub_u32 s68, s68, 1
    s_cmp_lg_u32 s68, 0
    s_waitcnt vmcnt(0)
    s_cbranch_scc1 tag_1
tagd_2:
    v_min_u32 v8, 31, v2
    v_lshlrev_b32 v8, 7, v8
    s_lshl_b32 s42, s4, 12
    s_add_u32 s42, s42, 13762560
    buffer_load_dwordx2 v[30:31], v8, s[44:47], s42 offen sc1
    s_add_u32 m0, s83, 65536
    s_add_u32 s68, s82, 0
    buffer_load_dwordx4 v24, s[92:95], s68 offen  lds
    s_add_u32 m0, s83, 66560
    s_add_u32 s68, s82, 8192
    buffer_load_dwordx4 v24, s[92:95], s68 offen  lds
    s_add_u32 m0, s83, 67584
    s_add_u32 s68, s82, 16384
    buffer_load_dwordx4 v24, s[92:95], s68 offen  lds
    s_add_u32 m0, s83, 68608
    s_add_u32 s68, s82, 24576
    buffer_load_dwordx4 v24, s[92:95], s68 offen  lds
    s_barrier
    s_add_u32 m0, s83, 81920
    s_add_u32 s68, s82, 32768
    buffer_load_dwordx4 v24, s[92:95], s68 offen  lds
    s_add_u32 m0, s83, 82944
    s_add_u32 s68, s82, 40960
    buffer_load_dwordx4 v24, s[92:95], s68 offen  lds
    s_add_u32 m0, s83, 83968
    s_add_u32 s68, s82, 49152
    buffer_load_dwordx4 v24, s[92:95], s68 offen  lds
    s_add_u32 m0, s83, 84992
    s_add_u32 s68, s82, 57344
    buffer_load_dwordx4 v24, s[92:95], s68 offen  lds
    s_barrier
    s_waitcnt vmcnt(8)
    s_mov_b32 s68, 200000
pl_3:
    v_cmp_ne_u64 vcc, s[6:7], v[30:31]
    s_cbranch_vccz pld_4
    s_sleep 4
    buffer_load_dwordx2 v[30:31], v8, s[44:47], s42 offen sc1
    s_sub_u32 s68, s68, 1
    s_cmp_lg_u32 s68, 0
    s_waitcnt vmcnt(0)
    s_cbranch_scc1 pl_3
pld_4:
    s_lshl_b32 s68, s8, 10
    s_add_u32 s68, s68, 12582912
    v_lshlrev_b32 v8, 4, v2
    buffer_load_dwordx4 v[124:127], v8, s[44:47], s68 offen sc1
    s_lshl_b32 s68, s43, 7
    s_mul_i32 s69, s90, 1060864
    s_add_u32 s68, s68, s69
    s_add_u32 s68, s68, 14680064
    s_add_u32 s69, s68, 530432
    v_lshrrev_b32 v8, 3, v2
    v_mul_u32_u24 v8, 66304, v8
    v_and_b32 v9, 7, v2
    v_lshl_add_u32 v8, v9, 4, v8
    buffer_load_dwordx4 v[114:117], v8, s[44:47], s68 offen sc1
    buffer_load_dwordx4 v[118:121], v8, s[44:47], s69 offen sc1
    v_lshlrev_b32 v8, 3, v2
    s_lshl_b32 s68, s76, 9
    s_add_u32 s68, s68, 12582912
    buffer_load_dwordx2 v[122:123], v8, s[44:47], s68 offen sc1
    s_add_u32 m0, s83, 0
    s_add_u32 s68, s82, 65536
    buffer_load_dwordx4 v24, s[92:95], s68 offen  lds
    s_add_u32 m0, s83, 1024
    s_add_u32 s68, s82, 73728
    buffer_load_dwordx4 v24, s[92:95], s68 offen  lds
    s_add_u32 m0, s83, 2048
    s_add_u32 s68, s82, 81920
    buffer_load_dwordx4 v24, s[92:95], s68 offen  lds
    s_add_u32 m0, s83, 3072
    s_add_u32 s68, s82, 90112
    buffer_load_dwordx4 v24, s[92:95], s68 offen  lds
    s_waitcnt vmcnt(4)
    v_mov_b32 v8, 161792
    ds_write_b64 v8, v[28:29]
    v_lshlrev_b32 v8, 4, v2
    v_add_u32 v8, 159744, v8
    ds_write_b128 v8, v[124:127]
    s_waitcnt lgkmcnt(0)
    s_barrier
    s_add_u32 m0, s83, 16384
    s_add_u32 s68, s82, 98304
    buffer_load_dwordx4 v24, s[92:95], s68 offen  lds
    s_add_u32 m0, s83, 17408
    s_add_u32 s68, s82, 106496
    buffer_load_dwordx4 v24, s[92:95], s68 offen  lds
    s_add_u32 m0, s83, 18432
    s_add_u32 s68, s82, 114688
    buffer_load_dwordx4 v24, s[92:95], s68 offen  lds
    s_add_u32 m0, s83, 19456
    s_add_u32 s68, s82, 122880
    buffer_load_dwordx4 v24, s[92:95], s68 offen  lds
    s_add_u32 m0, s83, 32768
    s_add_u32 s68, s82, 131072
    buffer_load_dwordx4 v24, s[92:95], s68 offen  lds
    s_add_u32 m0, s83, 33792
    s_add_u32 s68, s82, 139264
    buffer_load_dwordx4 v24, s[92:95], s68 offen  lds
    s_add_u32 m0, s83, 34816
    s_add_u32 s68, s82, 147456
    buffer_load_dwordx4 v24, s[92:95], s68 offen  lds
    s_add_u32 m0, s83, 35840
    s_add_u32 s68, s82, 155648
    buffer_load_dwordx4 v24, s[92:95], s68 offen  lds
    s_add_u32 m0, s83, 49152
    s_add_u32 s68, s82, 163840
    buffer_load_dwordx4 v24, s[92:95], s68 offen  lds
    s_add_u32 m0, s83, 50176
    s_add_u32 s68, s82, 172032
    buffer_load_dwordx4 v24, s[92:95], s68 offen  lds
    s_add_u32 m0, s83, 51200
    s_add_u32 s68, s82, 180224
    buffer_load_dwordx4 v24, s[92:95], s68 offen  lds
    s_add_u32 m0, s83, 52224
    s_add_u32 s68, s82, 188416
    buffer_load_dwordx4 v24, s[92:95], s68 offen  lds
    s_branch L_ph2b
L_g1:
    s_and_b32 s10, s3, 1
    s_lshr_b32 s11, s3, 1
    v_and_b32 v5, 7, v3
    v_xor_b32 v5, v1, v5
    v_lshlrev_b32 v5, 4, v5
    v_lshl_add_u32 v5, v3, 7, v5
    s_lshl_b32 s68, s10, 13
    s_add_u32 s68, s68, 98304
    s_lshl_b32 s69, s11, 12
    s_add_u32 s68, s68, s69
    v_add_u32 v8, s68, v5
    v_xor_b32 v9, 64, v8
    v_xor_b32 v10, 4096, v8
    v_xor_b32 v11, 4096, v9
    v_lshrrev_b32 v5, 2, v3
    v_lshl_add_u32 v6, v1, 3, v5
    v_lshlrev_b32 v6, 8, v6
    v_and_b32 v7, 1, v1
    v_lshl_or_b32 v5, v7, 2, v5
    s_lshl_b32 s68, s11, 2
    s_lshl_b32 s69, s10, 1
    s_or_b32 s68, s68, s69
    v_xor_b32 v5, s68, v5
    v_lshl_add_u32 v6, v5, 5, v6
    v_and_b32 v7, 3, v3
    v_lshl_add_u32 v12, v7, 3, v6
    v_xor_b32 v13, 32, v12
    v_xor_b32 v14, 64, v12
    v_xor_b32 v15, 96, v12
    v_mov_b32 v4, 0
    v_mov_b32 v5, 0
    s_setprio 2
    v_pk_mul_f32 v[128:129], v[4:5], v[4:5]
    v_pk_mul_f32 v[130:131], v[4:5], v[4:5]
    v_pk_mul_f32 v[132:133], v[4:5], v[4:5]
    v_pk_mul_f32 v[134:135], v[4:5], v[4:5]
    v_pk_mul_f32 v[136:137], v[4:5], v[4:5]
    v_pk_mul_f32 v[138:139], v[4:5], v[4:5]
    v_pk_mul_f32 v[140:141], v[4:5], v[4:5]
    v_pk_mul_f32 v[142:143], v[4:5], v[4:5]
    v_pk_mul_f32 v[144:145], v[4:5], v[4:5]
    v_pk_mul_f32 v[146:147], v[4:5], v[4:5]
    v_pk_mul_f32 v[148:149], v[4:5], v[4:5]
    v_pk_mul_f32 v[150:151], v[4:5], v[4:5]
    v_pk_mul_f32 v[152:153], v[4:5], v[4:5]
    v_pk_mul_f32 v[154:155], v[4:5], v[4:5]
    v_pk_mul_f32 v[156:157], v[4:5], v[4:5]
    v_pk_mul_f32 v[158:159], v[4:5], v[4:5]
    v_pk_mul_f32 v[160:161], v[4:5], v[4:5]
    v_pk_mul_f32 v[162:163], v[4:5], v[4:5]
    v_pk_mul_f32 v[164:165], v[4:5], v[4:5]
    v_pk_mul_f32 v[166:167], v[4:5], v[4:5]
    v_pk_mul_f32 v[168:169], v[4:5], v[4:5]
    v_pk_mul_f32 v[170:171], v[4:5], v[4:5]
    v_pk_mul_f32 v[172:173], v[4:5], v[4:5]
    v_pk_mul_f32 v[174:175], v[4:5], v[4:5]
    v_pk_mul_f32 v[176:177], v[4:5], v[4:5]
    v_pk_mul_f32 v[178:179], v[4:5], v[4:5]
    v_pk_mul_f32 v[180:181], v[4:5], v[4:5]
    v_pk_mul_f32 v[182:183], v[4:5], v[4:5]
    v_pk_mul_f32 v[184:185], v[4:5], v[4:5]
    v_pk_mul_f32 v[186:187], v[4:5], v[4:5]
    v_pk_mul_f32 v[188:189], v[4:5], v[4:5]
    v_pk_mul_f32 v[190:191], v[4:5], v[4:5]
    v_pk_mul_f32 v[192:193], v[4:5], v[4:5]
    v_pk_mul_f32 v[194:195], v[4:5], v[4:5]
    v_pk_mul_f32 v[196:197], v[4:5], v[4:5]
    v_pk_mul_f32 v[198:199], v[4:5], v[4:5]
    v_pk_mul_f32 v[200:201], v[4:5], v[4:5]
    v_pk_mul_f32 v[202:203], v[4:5], v[4:5]
    v_pk_mul_f32 v[204:205], v[4:5], v[4:5]
    v_pk_mul_f32 v[206:207], v[4:5], v[4:5]
    v_pk_mul_f32 v[208:209], v[4:5], v[4:5]
    v_pk_mul_f32 v[210:211], v[4:5], v[4:5]
    v_pk_mul_f32 v[212:213], v[4:5], v[4:5]
    v_pk_mul_f32 v[214:215], v[4:5], v[4:5]
    v_pk_mul_f32 v[216:217], v[4:5], v[4:5]
    v_pk_mul_f32 v[218:219], v[4:5], v[4:5]
    v_pk_mul_f32 v[220:221], v[4:5], v[4:5]
    v_pk_mul_f32 v[222:223], v[4:5], v[4:5]
    v_pk_mul_f32 v[224:225], v[4:5], v[4:5]
    v_pk_mul_f32 v[226:227], v[4:5], v[4:5]
    v_pk_mul_f32 v[228:229], v[4:5], v[4:5]
    v_pk_mul_f32 v[230:231], v[4:5], v[4:5]
    v_pk_mul_f32 v[232:233], v[4:5], v[4:5]
    v_pk_mul_f32 v[234:235], v[4:5], v[4:5]
    v_pk_mul_f32 v[236:237], v[4:5], v[4:5]
    v_pk_mul_f32 v[238:239], v[4:5], v[4:5]
    v_pk_mul_f32 v[240:241], v[4:5], v[4:5]
    v_pk_mul_f32 v[242:243], v[4:5], v[4:5]
    v_pk_mul_f32 v[244:245], v[4:5], v[4:5]
    v_pk_mul_f32 v[246:247], v[4:5], v[4:5]
    v_pk_mul_f32 v[248:249], v[4:5], v[4:5]
    v_pk_mul_f32 v[250:251], v[4:5], v[4:5]
    v_pk_mul_f32 v[252:253], v[4:5], v[4:5]
    v_pk_mul_f32 v[254:255], v[4:5], v[4:5]
    v_pk_mul_f32 v[16:17], v[4:5], v[4:5]
    v_pk_mul_f32 v[18:19], v[4:5], v[4:5]
    v_pk_mul_f32 v[20:21], v[4:5], v[4:5]
    v_pk_mul_f32 v[22:23], v[4:5], v[4:5]
    v_pk_mul_f32 v[24:25], v[4:5], v[4:5]
    v_pk_mul_f32 v[26:27], v[4:5], v[4:5]
    v_pk_mul_f32 v[28:29], v[4:5], v[4:5]
    v_pk_mul_f32 v[30:31], v[4:5], v[4:5]
    v_mov_b32 v4, 0x3f803f80
    v_mov_b32 v5, 0x3f803f80
    v_mov_b32 v6, 0x3f803f80
    v_mov_b32 v7, 0x3f803f80
    s_barrier
    ds_read_b128 v[32:35], v8 offset:0
    ds_read_b64_tr_b16 v[48:49], v12 offset:0
    ds_read_b64_tr_b16 v[50:51], v12 offset:1024
    ds_read_b64_tr_b16 v[52:53], v13 offset:0
    ds_read_b64_tr_b16 v[54:55], v13 offset:1024
    ds_read_b128 v[36:39], v8 offset:2048
    ds_read_b64_tr_b16 v[56:57], v14 offset:0
    ds_read_b64_tr_b16 v[58:59], v14 offset:1024
    ds_read_b64_tr_b16 v[60:61], v15 offset:0
    ds_read_b64_tr_b16 v[62:63], v15 offset:1024
    ds_read_b128 v[40:43], v10 offset:0
    ds_read_b64_tr_b16 v[64:65], v12 offset:8192
    ds_read_b64_tr_b16 v[66:67], v12 offset:9216
    ds_read_b64_tr_b16 v[68:69], v13 offset:8192
    ds_read_b64_tr_b16 v[70:71], v13 offset:9216
    ds_read_b128 v[44:47], v10 offset:2048
    ds_read_b64_tr_b16 v[72:73], v14 offset:8192
    ds_read_b64_tr_b16 v[74:75], v14 offset:9216
    ds_read_b64_tr_b16 v[76:77], v15 offset:8192
    ds_read_b64_tr_b16 v[78:79], v15 offset:9216
    s_mov_b32 s12, 0
    s_mov_b32 s13, 0
    s_mov_b32 s14, 0
    s_mov_b32 s43, 16384
L_g1loop:
    s_add_u32 s12, s12, 1
    s_cmp_eq_u32 s12, 6
    s_cselect_b32 s15, 4294885376, s43
    s_cselect_b32 s12, 0, s12
    v_add_u32 v12, s15, v12
    v_add_u32 v13, s15, v13
    v_add_u32 v14, s15, v14
    v_add_u32 v15, s15, v15
    s_waitcnt lgkmcnt(0)
    s_barrier
    v_mfma_f32_16x16x32_bf16 v[128:131], v[48:51], v[32:35], v[128:131]
    ds_read_b128 v[80:83], v9 offset:0
    v_mfma_f32_16x16x32_bf16 v[132:135], v[48:51], v[36:39], v[132:135]
    ds_read_b64_tr_b16 v[96:97], v12 offset:0
    v_mfma_f32_16x16x32_bf16 v[136:139], v[48:51], v[40:43], v[136:139]
    ds_read_b64_tr_b16 v[98:99], v12 offset:1024
    v_mfma_f32_16x16x32_bf16 v[140:143], v[48:51], v[44:47], v[140:143]
    ds_read_b64_tr_b16 v[100:101], v13 offset:0
    v_mfma_f32_16x16x32_bf16 v[16:19], v[48:51], v[4:7], v[16:19]
    v_mfma_f32_16x16x32_bf16 v[144:147], v[52:55], v[32:35], v[144:147]
    ds_read_b64_tr_b16 v[102:103], v13 offset:1024
    v_mfma_f32_16x16x32_bf16 v[148:151], v[52:55], v[36:39], v[148:151]
    ds_read_b128 v[84:87], v9 offset:2048
    v_mfma_f32_16x16x32_bf16 v[152:155], v[52:55], v[40:43], v[152:155]
    ds_read_b64_tr_b16 v[104:105], v14 offset:0
    v_mfma_f32_16x16x32_bf16 v[156:159], v[52:55], v[44:47], v[156:159]
    ds_read_b64_tr_b16 v[106:107], v14 offset:1024
    v_mfma_f32_16x16x32_bf16 v[20:23], v[52:55], v[4:7], v[20:23]
    v_mfma_f32_16x16x32_bf16 v[160:163], v[56:59], v[32:35], v[160:163]
    ds_read_b64_tr_b16 v[108:109], v15 offset:0
    v_mfma_f32_16x16x32_bf16 v[164:167], v[56:59], v[36:39], v[164:167]
    ds_read_b64_tr_b16 v[110:111], v15 offset:1024
    v_mfma_f32_16x16x32_bf16 v[168:171], v[56:59], v[40:43], v[168:171]
    ds_read_b128 v[88:91], v11 offset:0
    v_mfma_f32_16x16x32_bf16 v[172:175], v[56:59], v[44:47], v[172:175]
    ds_read_b64_tr_b16 v[112:113], v12 offset:8192
    v_mfma_f32_16x16x32_bf16 v[176:179], v[60:63], v[32:35], v[176:179]
    ds_read_b64_tr_b16 v[114:115], v12 offset:9216
    v_mfma_f32_16x16x32_bf16 v[180:183], v[60:63], v[36:39], v[180:183]
    ds_read_b64_tr_b16 v[116:117], v13 offset:8192
    v_mfma_f32_16x16x32_bf16 v[184:187], v[60:63], v[40:43], v[184:187]
    ds_read_b64_tr_b16 v[118:119], v13 offset:9216
    v_mfma_f32_16x16x32_bf16 v[188:191], v[60:63], v[44:47], v[188:191]
    ds_read_b128 v[92:95], v11 offset:2048
    v_mfma_f32_16x16x32_bf16 v[192:195], v[64:67], v[32:35], v[192:195]
    ds_read_b64_tr_b16 v[120:121], v14 offset:8192
    v_mfma_f32_16x16x32_bf16 v[196:199], v[64:67], v[36:39], v[196:199]
    ds_read_b64_tr_b16 v[122:123], v14 offset:9216
    v_mfma_f32_16x16x32_bf16 v[200:203], v[64:67], v[40:43], v[200:203]
    ds_read_b64_tr_b16 v[124:125], v15 offset:8192
    v_mfma_f32_16x16x32_bf16 v[204:207], v[64:67], v[44:47], v[204:207]
    ds_read_b64_tr_b16 v[126:127], v15 offset:9216
    v_mfma_f32_16x16x32_bf16 v[24:27], v[64:67], v[4:7], v[24:27]
    v_mfma_f32_16x16x32_bf16 v[208:211], v[68:71], v[32:35], v[208:211]
    v_mfma_f32_16x16x32_bf16 v[212:215], v[68:71], v[36:39], v[212:215]
    v_mfma_f32_16x16x32_bf16 v[216:219], v[68:71], v[40:43], v[216:219]
    v_mfma_f32_16x16x32_bf16 v[220:223], v[68:71], v[44:47], v[220:223]
    v_mfma_f32_16x16x32_bf16 v[28:31], v[68:71], v[4:7], v[28:31]
    v_mfma_f32_16x16x32_bf16 v[224:227], v[72:75], v[32:35], v[224:227]
    v_mfma_f32_16x16x32_bf16 v[228:231], v[72:75], v[36:39], v[228:231]
    v_mfma_f32_16x16x32_bf16 v[232:235], v[72:75], v[40:43], v[232:235]
    v_mfma_f32_16x16x32_bf16 v[236:239], v[72:75], v[44:47], v[236:239]
    v_mfma_f32_16x16x32_bf16 v[240:243], v[76:79], v[32:35], v[240:243]
    v_mfma_f32_16x16x32_bf16 v[244:247], v[76:79], v[36:39], v[244:247]
    v_mfma_f32_16x16x32_bf16 v[248:251], v[76:79], v[40:43], v[248:251]
    v_mfma_f32_16x16x32_bf16 v[252:255], v[76:79], v[44:47], v[252:255]
    s_add_u32 s12, s12, 1
    s_cmp_eq_u32 s12, 6
    s_cselect_b32 s15, 4294885376, s43
    s_cselect_b32 s12, 0, s12
    s_add_u32 s14, s14, 1
    s_cmp_eq_u32 s14, 3
    s_cselect_b32 s42, 4294934528, s43
    s_cselect_b32 s14, 0, s14
    v_add_u32 v12, s15, v12
    v_add_u32 v13, s15, v13
    v_add_u32 v14, s15, v14
    v_add_u32 v15, s15, v15
    v_add_u32 v8, s42, v8
    v_add_u32 v9, s42, v9
    v_add_u32 v10, s42, v10
    v_add_u32 v11, s42, v11
    s_waitcnt lgkmcnt(0)
    s_barrier
    v_mfma_f32_16x16x32_bf16 v[128:131], v[96:99], v[80:83], v[128:131]
    ds_read_b128 v[32:35], v8 offset:0
    v_mfma_f32_16x16x32_bf16 v[132:135], v[96:99], v[84:87], v[132:135]
    ds_read_b64_tr_b16 v[48:49], v12 offset:0
    v_mfma_f32_16x16x32_bf16 v[136:139], v[96:99], v[88:91], v[136:139]
    ds_read_b64_tr_b16 v[50:51], v12 offset:1024
    v_mfma_f32_16x16x32_bf16 v[140:143], v[96:99], v[92:95], v[140:143]
    ds_read_b64_tr_b16 v[52:53], v13 offset:0
    v_mfma_f32_16x16x32_bf16 v[16:19], v[96:99], v[4:7], v[16:19]
    v_mfma_f32_16x16x32_bf16 v[144:147], v[100:103], v[80:83], v[144:147]
    ds_read_b64_tr_b16 v[54:55], v13 offset:1024
    v_mfma_f32_16x16x32_bf16 v[148:151], v[100:103], v[84:87], v[148:151]
    ds_read_b128 v[36:39], v8 offset:2048
    v_mfma_f32_16x16x32_bf16 v[152:155], v[100:103], v[88:91], v[152:155]
    ds_read_b64_tr_b16 v[56:57], v14 offset:0
    v_mfma_f32_16x16x32_bf16 v[156:159], v[100:103], v[92:95], v[156:159]
    ds_read_b64_tr_b16 v[58:59], v14 offset:1024
    v_mfma_f32_16x16x32_bf16 v[20:23], v[100:103], v[4:7], v[20:23]
    v_mfma_f32_16x16x32_bf16 v[160:163], v[104:107], v[80:83], v[160:163]
    ds_read_b64_tr_b16 v[60:61], v15 offset:0
    v_mfma_f32_16x16x32_bf16 v[164:167], v[104:107], v[84:87], v[164:167]
    ds_read_b64_tr_b16 v[62:63], v15 offset:1024
    v_mfma_f32_16x16x32_bf16 v[168:171], v[104:107], v[88:91], v[168:171]
    ds_read_b128 v[40:43], v10 offset:0
    v_mfma_f32_16x16x32_bf16 v[172:175], v[104:107], v[92:95], v[172:175]
    ds_read_b64_tr_b16 v[64:65], v12 offset:8192
    v_mfma_f32_16x16x32_bf16 v[176:179], v[108:111], v[80:83], v[176:179]
    ds_read_b64_tr_b16 v[66:67], v12 offset:9216
    v_mfma_f32_16x16x32_bf16 v[180:183], v[108:111], v[84:87], v[180:183]
    ds_read_b64_tr_b16 v[68:69], v13 offset:8192
    v_mfma_f32_16x16x32_bf16 v[184:187], v[108:111], v[88:91], v[184:187]
    ds_read_b64_tr_b16 v[70:71], v13 offset:9216
    v_mfma_f32_16x16x32_bf16 v[188:191], v[108:111], v[92:95], v[188:191]
    ds_read_b128 v[44:47], v10 offset:2048
    v_mfma_f32_16x16x32_bf16 v[192:195], v[112:115], v[80:83], v[192:195]
    ds_read_b64_tr_b16 v[72:73], v14 offset:8192
    v_mfma_f32_16x16x32_bf16 v[196:199], v[112:115], v[84:87], v[196:199]
    ds_read_b64_tr_b16 v[74:75], v14 offset:9216
    v_mfma_f32_16x16x32_bf16 v[200:203], v[112:115], v[88:91], v[200:203]
    ds_read_b64_tr_b16 v[76:77], v15 offset:8192
    v_mfma_f32_16x16x32_bf16 v[204:207], v[112:115], v[92:95], v[204:207]
    ds_read_b64_tr_b16 v[78:79], v15 offset:9216
    v_mfma_f32_16x16x32_bf16 v[24:27], v[112:115], v[4:7], v[24:27]
    v_mfma_f32_16x16x32_bf16 v[208:211], v[116:119], v[80:83], v[208:211]
    v_mfma_f32_16x16x32_bf16 v[212:215], v[116:119], v[84:87], v[212:215]
    v_mfma_f32_16x16x32_bf16 v[216:219], v[116:119], v[88:91], v[216:219]
    v_mfma_f32_16x16x32_bf16 v[220:223], v[116:119], v[92:95], v[220:223]
    v_mfma_f32_16x16x32_bf16 v[28:31], v[116:119], v[4:7], v[28:31]
    v_mfma_f32_16x16x32_bf16 v[224:227], v[120:123], v[80:83], v[224:227]
    v_mfma_f32_16x16x32_bf16 v[228:231], v[120:123], v[84:87], v[228:231]
    v_mfma_f32_16x16x32_bf16 v[232:235], v[120:123], v[88:91], v[232:235]
    v_mfma_f32_16x16x32_bf16 v[236:239], v[120:123], v[92:95], v[236:239]
    v_mfma_f32_16x16x32_bf16 v[240:243], v[124:127], v[80:83], v[240:243]
    v_mfma_f32_16x16x32_bf16 v[244:247], v[124:127], v[84:87], v[244:247]
    v_mfma_f32_16x16x32_bf16 v[248:251], v[124:127], v[88:91], v[248:251]
    v_mfma_f32_16x16x32_bf16 v[252:255], v[124:127], v[92:95], v[252:255]
    s_add_u32 s13, s13, 1
    s_cmp_lt_u32 s13, 8
    s_cbranch_scc1 L_g1loop
    s_waitcnt lgkmcnt(0)
    s_lshl_b32 s68, s10, 9
    s_lshl_b32 s69, s11, 8
    s_add_u32 s68, s68, s69
    s_add_u32 s68, s68, 159744
    v_lshl_add_u32 v4, v3, 3, s68
    v_xor_b32 v5, 256, v4
    s_lshl_b32 s68, s10, 7
    s_add_u32 s68, s68, s69
    s_add_u32 s68, s68, 160768
    v_lshl_add_u32 v6, v1, 4, s68
    v_xor_b32 v7, 128, v6
    v_mov_b32 v8, 161792
    ds_write_b128 v6, v[16:19]
    ds_write_b128 v6, v[20:23] offset:64
    ds_write_b128 v6, v[24:27] offset:512
    ds_write_b128 v6, v[28:31] offset:576
    s_waitcnt lgkmcnt(0)
    s_barrier
    ds_read_b64 v[14:15], v8
    ds_read_b64 v[16:17], v4 offset:0
    ds_read_b64 v[18:19], v4 offset:128
    ds_read_b64 v[20:21], v5 offset:0
    ds_read_b64 v[22:23], v5 offset:128
    ds_read_b128 v[32:35], v6 offset:0
    ds_read_b128 v[36:39], v6 offset:64
    ds_read_b128 v[40:43], v7 offset:0
    ds_read_b128 v[44:47], v7 offset:64
    ds_read_b128 v[48:51], v6 offset:512
    ds_read_b128 v[52:55], v6 offset:576
    ds_read_b128 v[56:59], v7 offset:512
    ds_read_b128 v[60:63], v7 offset:576
    s_mov_b32 s86, 3222493025
    s_mov_b32 s87, 3222493025
    v_mov_b32 v8, 3184710632
    v_mov_b32 v9, 3184710632
    s_lshl_b32 s68, s8, 3
    s_lshl_b32 s69, s10, 2
    s_add_u32 s68, s68, s69
    s_mul_i32 s68, s68, 56
    s_lshl_b32 s69, s9, 2
    s_add_u32 s68, s68, s69
    s_lshl_b32 s69, s11, 1
    s_add_u32 s68, s68, s69
    s_lshl_b32 s85, s68, 10
    s_mul_i32 s68, s11, 114688
    s_sub_u32 s84, s85, s68
    s_add_u32 s84, s84, 114688
    s_add_u32 s85, s85, s68
    s_lshl_b32 s68, s10, 10
    v_lshl_add_u32 v26, v2, 4, s68
    v_xor_b32 v27, 1024, v26
    s_waitcnt lgkmcnt(0)
    v_readfirstlane_b32 s6, v14
    v_readfirstlane_b32 s7, v15
    v_rcp_f32 v10, v17
    v_rcp_f32 v11, v19
    v_rcp_f32 v12, v21
    v_rcp_f32 v13, v23
    v_pk_fma_f32 v[128:129], v[32:33], v[16:17], v[128:129] op_sel_hi:[1,0,1] neg_lo:[0,1,0] neg_hi:[0,1,0]
    v_pk_fma_f32 v[130:131], v[34:35], v[16:17], v[130:131] op_sel_hi:[1,0,1] neg_lo:[0,1,0] neg_hi:[0,1,0]
    v_pk_fma_f32 v[144:145], v[36:37], v[16:17], v[144:145] op_sel_hi:[1,0,1] neg_lo:[0,1,0] neg_hi:[0,1,0]
    v_pk_fma_f32 v[146:147], v[38:39], v[16:17], v[146:147] op_sel_hi:[1,0,1] neg_lo:[0,1,0] neg_hi:[0,1,0]
    v_pk_mul_f32 v[128:129], v[128:129], v[16:17] op_sel:[0,1] op_sel_hi:[1,1]
    v_pk_mul_f32 v[130:131], v[130:131], v[16:17] op_sel:[0,1] op_sel_hi:[1,1]
    v_pk_mul_f32 v[144:145], v[144:145], v[16:17] op_sel:[0,1] op_sel_hi:[1,1]
    v_pk_mul_f32 v[146:147], v[146:147], v[16:17] op_sel:[0,1] op_sel_hi:[1,1]
    v_pk_mul_f32 v[80:81], v[128:129], v[128:129]
    v_pk_mul_f32 v[82:83], v[130:131], v[130:131]
    v_pk_mul_f32 v[84:85], v[144:145], v[144:145]
    v_pk_mul_f32 v[86:87], v[146:147], v[146:147]
    v_pk_fma_f32 v[80:81], v[80:81], v[8:9], s[86:87]
    v_pk_fma_f32 v[82:83], v[82:83], v[8:9], s[86:87]
    v_pk_fma_f32 v[84:85], v[84:85], v[8:9], s[86:87]
    v_pk_fma_f32 v[86:87], v[86:87], v[8:9], s[86:87]
    v_pk_mul_f32 v[80:81], v[80:81], v[128:129]
    v_pk_mul_f32 v[82:83], v[82:83], v[130:131]
    v_pk_mul_f32 v[84:85], v[84:85], v[144:145]
    v_pk_mul_f32 v[86:87], v[86:87], v[146:147]
    v_exp_f32 v80, v80
    v_exp_f32 v81, v81
    v_pk_fma_f32 v[192:193], v[48:49], v[16:17], v[192:193] op_sel_hi:[1,0,1] neg_lo:[0,1,0] neg_hi:[0,1,0]
    v_exp_f32 v82, v82
    v_exp_f32 v83, v83
    v_pk_fma_f32 v[194:195], v[50:51], v[16:17], v[194:195] op_sel_hi:[1,0,1] neg_lo:[0,1,0] neg_hi:[0,1,0]
    v_exp_f32 v84, v84
    v_exp_f32 v85, v85
    v_pk_fma_f32 v[208:209], v[52:53], v[16:17], v[208:209] op_sel_hi:[1,0,1] neg_lo:[0,1,0] neg_hi:[0,1,0]
    v_exp_f32 v86, v86
    v_exp_f32 v87, v87
    v_pk_fma_f32 v[210:211], v[54:55], v[16:17], v[210:211] op_sel_hi:[1,0,1] neg_lo:[0,1,0] neg_hi:[0,1,0]
    v_fma_f32 v80, v80, v10, v10
    v_fma_f32 v81, v81, v10, v10
    v_fma_f32 v82, v82, v10, v10
    v_fma_f32 v83, v83, v10, v10
    v_fma_f32 v84, v84, v10, v10
    v_fma_f32 v85, v85, v10, v10
    v_fma_f32 v86, v86, v10, v10
    v_fma_f32 v87, v87, v10, v10
    v_rcp_f32 v80, v80
    v_rcp_f32 v81, v81
    v_pk_mul_f32 v[128:129], v[128:129], v[192:193]
    v_rcp_f32 v82, v82
    v_rcp_f32 v83, v83
    v_pk_mul_f32 v[130:131], v[130:131], v[194:195]
    v_rcp_f32 v84, v84
    v_rcp_f32 v85, v85
    v_pk_mul_f32 v[144:145], v[144:145], v[208:209]
    v_rcp_f32 v86, v86
    v_rcp_f32 v87, v87
    v_pk_mul_f32 v[146:147], v[146:147], v[210:211]
    v_pk_mul_f32 v[128:129], v[128:129], v[80:81]
    v_pk_mul_f32 v[130:131], v[130:131], v[82:83]
    v_pk_mul_f32 v[144:145], v[144:145], v[84:85]
    v_pk_mul_f32 v[146:147], v[146:147], v[86:87]
    v_cvt_pk_bf16_f32 v64, v128, v129
    v_cvt_pk_bf16_f32 v65, v130, v131
    v_cvt_pk_bf16_f32 v66, v144, v145
    v_cvt_pk_bf16_f32 v67, v146, v147
    s_add_u32 s68, s85, 0
    buffer_store_dwordx4 v[64:67], v26, s[44:47], s68 offen sc1
    v_pk_fma_f32 v[160:161], v[40:41], v[16:17], v[160:161] op_sel_hi:[1,0,1] neg_lo:[0,1,0] neg_hi:[0,1,0]
    v_pk_fma_f32 v[162:163], v[42:43], v[16:17], v[162:163] op_sel_hi:[1,0,1] neg_lo:[0,1,0] neg_hi:[0,1,0]
    v_pk_fma_f32 v[176:177], v[44:45], v[16:17], v[176:177] op_sel_hi:[1,0,1] neg_lo:[0,1,0] neg_hi:[0,1,0]
    v_pk_fma_f32 v[178:179], v[46:47], v[16:17], v[178:179] op_sel_hi:[1,0,1] neg_lo:[0,1,0] neg_hi:[0,1,0]
    v_pk_mul_f32 v[160:161], v[160:161], v[16:17] op_sel:[0,1] op_sel_hi:[1,1]
    v_pk_mul_f32 v[162:163], v[162:163], v[16:17] op_sel:[0,1] op_sel_hi:[1,1]
    v_pk_mul_f32 v[176:177], v[176:177], v[16:17] op_sel:[0,1] op_sel_hi:[1,1]
    v_pk_mul_f32 v[178:179], v[178:179], v[16:17] op_sel:[0,1] op_sel_hi:[1,1]
    v_pk_mul_f32 v[80:81], v[160:161], v[160:161]
    v_pk_mul_f32 v[82:83], v[162:163], v[162:163]
    v_pk_mul_f32 v[84:85], v[176:177], v[176:177]
    v_pk_mul_f32 v[86:87], v[178:179], v[178:179]
    v_pk_fma_f32 v[80:81], v[80:81], v[8:9], s[86:87]
    v_pk_fma_f32 v[82:83], v[82:83], v[8:9], s[86:87]
    v_pk_fma_f32 v[84:85], v[84:85], v[8:9], s[86:87]
    v_pk_fma_f32 v[86:87], v[86:87], v[8:9], s[86:87]
    v_pk_mul_f32 v[80:81], v[80:81], v[160:161]
    v_pk_mul_f32 v[82:83], v[82:83], v[162:163]
    v_pk_mul_f32 v[84:85], v[84:85], v[176:177]
    v_pk_mul_f32 v[86:87], v[86:87], v[178:179]
    v_exp_f32 v80, v80
    v_exp_f32 v81, v81
    v_pk_fma_f32 v[224:225], v[56:57], v[16:17], v[224:225] op_sel_hi:[1,0,1] neg_lo:[0,1,0] neg_hi:[0,1,0]
    v_exp_f32 v82, v82
    v_exp_f32 v83, v83
    v_pk_fma_f32 v[226:227], v[58:59], v[16:17], v[226:227] op_sel_hi:[1,0,1] neg_lo:[0,1,0] neg_hi:[0,1,0]
    v_exp_f32 v84, v84
    v_exp_f32 v85, v85
    v_pk_fma_f32 v[240:241], v[60:61], v[16:17], v[240:241] op_sel_hi:[1,0,1] neg_lo:[0,1,0] neg_hi:[0,1,0]
    v_exp_f32 v86, v86
    v_exp_f32 v87, v87
    v_pk_fma_f32 v[242:243], v[62:63], v[16:17], v[242:243] op_sel_hi:[1,0,1] neg_lo:[0,1,0] neg_hi:[0,1,0]
    v_fma_f32 v80, v80, v10, v10
    v_fma_f32 v81, v81, v10, v10
    v_fma_f32 v82, v82, v10, v10
    v_fma_f32 v83, v83, v10, v10
    v_fma_f32 v84, v84, v10, v10
    v_fma_f32 v85, v85, v10, v10
    v_fma_f32 v86, v86, v10, v10
    v_fma_f32 v87, v87, v10, v10
    v_rcp_f32 v80, v80
    v_rcp_f32 v81, v81
    v_pk_mul_f32 v[160:161], v[160:161], v[224:225]
    v_rcp_f32 v82, v82
    v_rcp_f32 v83, v83
    v_pk_mul_f32 v[162:163], v[162:163], v[226:227]
    v_rcp_f32 v84, v84
    v_rcp_f32 v85, v85
    v_pk_mul_f32 v[176:177], v[176:177], v[240:241]
    v_rcp_f32 v86, v86
    v_rcp_f32 v87, v87
    v_pk_mul_f32 v[178:179], v[178:179], v[242:243]
    v_pk_mul_f32 v[160:161], v[160:161], v[80:81]
    v_pk_mul_f32 v[162:163], v[162:163], v[82:83]
    v_pk_mul_f32 v[176:177], v[176:177], v[84:85]
    v_pk_mul_f32 v[178:179], v[178:179], v[86:87]
    v_cvt_pk_bf16_f32 v68, v160, v161
    v_cvt_pk_bf16_f32 v69, v162, v163
    v_cvt_pk_bf16_f32 v70, v176, v177
    v_cvt_pk_bf16_f32 v71, v178, v179
    s_add_u32 s68, s85, 0
    buffer_store_dwordx4 v[68:71], v27, s[44:47], s68 offen sc1
    v_pk_fma_f32 v[132:133], v[32:33], v[18:19], v[132:133] op_sel_hi:[1,0,1] neg_lo:[0,1,0] neg_hi:[0,1,0]
    v_pk_fma_f32 v[134:135], v[34:35], v[18:19], v[134:135] op_sel_hi:[1,0,1] neg_lo:[0,1,0] neg_hi:[0,1,0]
    v_pk_fma_f32 v[148:149], v[36:37], v[18:19], v[148:149] op_sel_hi:[1,0,1] neg_lo:[0,1,0] neg_hi:[0,1,0]
    v_pk_fma_f32 v[150:151], v[38:39], v[18:19], v[150:151] op_sel_hi:[1,0,1] neg_lo:[0,1,0] neg_hi:[0,1,0]
    v_pk_mul_f32 v[132:133], v[132:133], v[18:19] op_sel:[0,1] op_sel_hi:[1,1]
    v_pk_mul_f32 v[134:135], v[134:135], v[18:19] op_sel:[0,1] op_sel_hi:[1,1]
    v_pk_mul_f32 v[148:149], v[148:149], v[18:19] op_sel:[0,1] op_sel_hi:[1,1]
    v_pk_mul_f32 v[150:151], v[150:151], v[18:19] op_sel:[0,1] op_sel_hi:[1,1]
    v_pk_mul_f32 v[80:81], v[132:133], v[132:133]
    v_pk_mul_f32 v[82:83], v[134:135], v[134:135]
    v_pk_mul_f32 v[84:85], v[148:149], v[148:149]
    v_pk_mul_f32 v[86:87], v[150:151], v[150:151]
    v_pk_fma_f32 v[80:81], v[80:81], v[8:9], s[86:87]
    v_pk_fma_f32 v[82:83], v[82:83], v[8:9], s[86:87]
    v_pk_fma_f32 v[84:85], v[84:85], v[8:9], s[86:87]
    v_pk_fma_f32 v[86:87], v[86:87], v[8:9], s[86:87]
    v_pk_mul_f32 v[80:81], v[80:81], v[132:133]
    v_pk_mul_f32 v[82:83], v[82:83], v[134:135]
    v_pk_mul_f32 v[84:85], v[84:85], v[148:149]
    v_pk_mul_f32 v[86:87], v[86:87], v[150:151]
    v_exp_f32 v80, v80
    v_exp_f32 v81, v81
    v_pk_fma_f32 v[196:197], v[48:49], v[18:19], v[196:197] op_sel_hi:[1,0,1] neg_lo:[0,1,0] neg_hi:[0,1,0]
    v_exp_f32 v82, v82
    v_exp_f32 v83, v83
    v_pk_fma_f32 v[198:199], v[50:51], v[18:19], v[198:199] op_sel_hi:[1,0,1] neg_lo:[0,1,0] neg_hi:[0,1,0]
    v_exp_f32 v84, v84
    v_exp_f32 v85, v85
    v_pk_fma_f32 v[212:213], v[52:53], v[18:19], v[212:213] op_sel_hi:[1,0,1] neg_lo:[0,1,0] neg_hi:[0,1,0]
    v_exp_f32 v86, v86
    v_exp_f32 v87, v87
    v_pk_fma_f32 v[214:215], v[54:55], v[18:19], v[214:215] op_sel_hi:[1,0,1] neg_lo:[0,1,0] neg_hi:[0,1,0]
    v_fma_f32 v80, v80, v11, v11
    v_fma_f32 v81, v81, v11, v11
    v_fma_f32 v82, v82, v11, v11
    v_fma_f32 v83, v83, v11, v11
    v_fma_f32 v84, v84, v11, v11
    v_fma_f32 v85, v85, v11, v11
    v_fma_f32 v86, v86, v11, v11
    v_fma_f32 v87, v87, v11, v11
    v_rcp_f32 v80, v80
    v_rcp_f32 v81, v81
    v_pk_mul_f32 v[132:133], v[132:133], v[196:197]
    v_rcp_f32 v82, v82
    v_rcp_f32 v83, v83
    v_pk_mul_f32 v[134:135], v[134:135], v[198:199]
    v_rcp_f32 v84, v84
    v_rcp_f32 v85, v85
    v_pk_mul_f32 v[148:149], v[148:149], v[212:213]
    v_rcp_f32 v86, v86
    v_rcp_f32 v87, v87
    v_pk_mul_f32 v[150:151], v[150:151], v[214:215]
    v_pk_mul_f32 v[132:133], v[132:133], v[80:81]
    v_pk_mul_f32 v[134:135], v[134:135], v[82:83]
    v_pk_mul_f32 v[148:149], v[148:149], v[84:85]
    v_pk_mul_f32 v[150:151], v[150:151], v[86:87]
    v_cvt_pk_bf16_f32 v64, v132, v133
    v_cvt_pk_bf16_f32 v65, v134, v135
    v_cvt_pk_bf16_f32 v66, v148, v149
    v_cvt_pk_bf16_f32 v67, v150, v151
    s_add_u32 s68, s85, 57344
    buffer_store_dwordx4 v[64:67], v26, s[44:47], s68 offen sc1
    v_pk_fma_f32 v[164:165], v[40:41], v[18:19], v[164:165] op_sel_hi:[1,0,1] neg_lo:[0,1,0] neg_hi:[0,1,0]
    v_pk_fma_f32 v[166:167], v[42:43], v[18:19], v[166:167] op_sel_hi:[1,0,1] neg_lo:[0,1,0] neg_hi:[0,1,0]
    v_pk_fma_f32 v[180:181], v[44:45], v[18:19], v[180:181] op_sel_hi:[1,0,1] neg_lo:[0,1,0] neg_hi:[0,1,0]
    v_pk_fma_f32 v[182:183], v[46:47], v[18:19], v[182:183] op_sel_hi:[1,0,1] neg_lo:[0,1,0] neg_hi:[0,1,0]
    v_pk_mul_f32 v[164:165], v[164:165], v[18:19] op_sel:[0,1] op_sel_hi:[1,1]
    v_pk_mul_f32 v[166:167], v[166:167], v[18:19] op_sel:[0,1] op_sel_hi:[1,1]
    v_pk_mul_f32 v[180:181], v[180:181], v[18:19] op_sel:[0,1] op_sel_hi:[1,1]
    v_pk_mul_f32 v[182:183], v[182:183], v[18:19] op_sel:[0,1] op_sel_hi:[1,1]
    v_pk_mul_f32 v[80:81], v[164:165], v[164:165]
    v_pk_mul_f32 v[82:83], v[166:167], v[166:167]
    v_pk_mul_f32 v[84:85], v[180:181], v[180:181]
    v_pk_mul_f32 v[86:87], v[182:183], v[182:183]
    v_pk_fma_f32 v[80:81], v[80:81], v[8:9], s[86:87]
    v_pk_fma_f32 v[82:83], v[82:83], v[8:9], s[86:87]
    v_pk_fma_f32 v[84:85], v[84:85], v[8:9], s[86:87]
    v_pk_fma_f32 v[86:87], v[86:87], v[8:9], s[86:87]
    v_pk_mul_f32 v[80:81], v[80:81], v[164:165]
    v_pk_mul_f32 v[82:83], v[82:83], v[166:167]
    v_pk_mul_f32 v[84:85], v[84:85], v[180:181]
    v_pk_mul_f32 v[86:87], v[86:87], v[182:183]
    v_exp_f32 v80, v80
    v_exp_f32 v81, v81
    v_pk_fma_f32 v[228:229], v[56:57], v[18:19], v[228:229] op_sel_hi:[1,0,1] neg_lo:[0,1,0] neg_hi:[0,1,0]
    v_exp_f32 v82, v82
    v_exp_f32 v83, v83
    v_pk_fma_f32 v[230:231], v[58:59], v[18:19], v[230:231] op_sel_hi:[1,0,1] neg_lo:[0,1,0] neg_hi:[0,1,0]
    v_exp_f32 v84, v84
    v_exp_f32 v85, v85
    v_pk_fma_f32 v[244:245], v[60:61], v[18:19], v[244:245] op_sel_hi:[1,0,1] neg_lo:[0,1,0] neg_hi:[0,1,0]
    v_exp_f32 v86, v86
    v_exp_f32 v87, v87
    v_pk_fma_f32 v[246:247], v[62:63], v[18:19], v[246:247] op_sel_hi:[1,0,1] neg_lo:[0,1,0] neg_hi:[0,1,0]
    v_fma_f32 v80, v80, v11, v11
    v_fma_f32 v81, v81, v11, v11
    v_fma_f32 v82, v82, v11, v11
    v_fma_f32 v83, v83, v11, v11
    v_fma_f32 v84, v84, v11, v11
    v_fma_f32 v85, v85, v11, v11
    v_fma_f32 v86, v86, v11, v11
    v_fma_f32 v87, v87, v11, v11
    v_rcp_f32 v80, v80
    v_rcp_f32 v81, v81
    v_pk_mul_f32 v[164:165], v[164:165], v[228:229]
    v_rcp_f32 v82, v82
    v_rcp_f32 v83, v83
    v_pk_mul_f32 v[166:167], v[166:167], v[230:231]
    v_rcp_f32 v84, v84
    v_rcp_f32 v85, v85
    v_pk_mul_f32 v[180:181], v[180:181], v[244:245]
    v_rcp_f32 v86, v86
    v_rcp_f32 v87, v87
    v_pk_mul_f32 v[182:183], v[182:183], v[246:247]
    v_pk_mul_f32 v[164:165], v[164:165], v[80:81]
    v_pk_mul_f32 v[166:167], v[166:167], v[82:83]
    v_pk_mul_f32 v[180:181], v[180:181], v[84:85]
    v_pk_mul_f32 v[182:183], v[182:183], v[86:87]
    v_cvt_pk_bf16_f32 v68, v164, v165
    v_cvt_pk_bf16_f32 v69, v166, v167
    v_cvt_pk_bf16_f32 v70, v180, v181
    v_cvt_pk_bf16_f32 v71, v182, v183
    s_add_u32 s68, s85, 57344
    buffer_store_dwordx4 v[68:71], v27, s[44:47], s68 offen sc1
    v_pk_fma_f32 v[136:137], v[32:33], v[20:21], v[136:137] op_sel_hi:[1,0,1] neg_lo:[0,1,0] neg_hi:[0,1,0]
    v_pk_fma_f32 v[138:139], v[34:35], v[20:21], v[138:139] op_sel_hi:[1,0,1] neg_lo:[0,1,0] neg_hi:[0,1,0]
    v_pk_fma_f32 v[152:153], v[36:37], v[20:21], v[152:153] op_sel_hi:[1,0,1] neg_lo:[0,1,0] neg_hi:[0,1,0]
    v_pk_fma_f32 v[154:155], v[38:39], v[20:21], v[154:155] op_sel_hi:[1,0,1] neg_lo:[0,1,0] neg_hi:[0,1,0]
    v_pk_mul_f32 v[136:137], v[136:137], v[20:21] op_sel:[0,1] op_sel_hi:[1,1]
    v_pk_mul_f32 v[138:139], v[138:139], v[20:21] op_sel:[0,1] op_sel_hi:[1,1]
    v_pk_mul_f32 v[152:153], v[152:153], v[20:21] op_sel:[0,1] op_sel_hi:[1,1]
    v_pk_mul_f32 v[154:155], v[154:155], v[20:21] op_sel:[0,1] op_sel_hi:[1,1]
    v_pk_mul_f32 v[80:81], v[136:137], v[136:137]
    v_pk_mul_f32 v[82:83], v[138:139], v[138:139]
    v_pk_mul_f32 v[84:85], v[152:153], v[152:153]
    v_pk_mul_f32 v[86:87], v[154:155], v[154:155]
    v_pk_fma_f32 v[80:81], v[80:81], v[8:9], s[86:87]
    v_pk_fma_f32 v[82:83], v[82:83], v[8:9], s[86:87]
    v_pk_fma_f32 v[84:85], v[84:85], v[8:9], s[86:87]
    v_pk_fma_f32 v[86:87], v[86:87], v[8:9], s[86:87]
    v_pk_mul_f32 v[80:81], v[80:81], v[136:137]
    v_pk_mul_f32 v[82:83], v[82:83], v[138:139]
    v_pk_mul_f32 v[84:85], v[84:85], v[152:153]
    v_pk_mul_f32 v[86:87], v[86:87], v[154:155]
    v_exp_f32 v80, v80
    v_exp_f32 v81, v81
    v_pk_fma_f32 v[200:201], v[48:49], v[20:21], v[200:201] op_sel_hi:[1,0,1] neg_lo:[0,1,0] neg_hi:[0,1,0]
    v_exp_f32 v82, v82
    v_exp_f32 v83, v83
    v_pk_fma_f32 v[202:203], v[50:51], v[20:21], v[202:203] op_sel_hi:[1,0,1] neg_lo:[0,1,0] neg_hi:[0,1,0]
    v_exp_f32 v84, v84
    v_exp_f32 v85, v85
    v_pk_fma_f32 v[216:217], v[52:53], v[20:21], v[216:217] op_sel_hi:[1,0,1] neg_lo:[0,1,0] neg_hi:[0,1,0]
    v_exp_f32 v86, v86
    v_exp_f32 v87, v87
    v_pk_fma_f32 v[218:219], v[54:55], v[20:21], v[218:219] op_sel_hi:[1,0,1] neg_lo:[0,1,0] neg_hi:[0,1,0]
    v_fma_f32 v80, v80, v12, v12
    v_fma_f32 v81, v81, v12, v12
    v_fma_f32 v82, v82, v12, v12
    v_fma_f32 v83, v83, v12, v12
    v_fma_f32 v84, v84, v12, v12
    v_fma_f32 v85, v85, v12, v12
    v_fma_f32 v86, v86, v12, v12
    v_fma_f32 v87, v87, v12, v12
    v_rcp_f32 v80, v80
    v_rcp_f32 v81, v81
    v_pk_mul_f32 v[136:137], v[136:137], v[200:201]
    v_rcp_f32 v82, v82
    v_rcp_f32 v83, v83
    v_pk_mul_f32 v[138:139], v[138:139], v[202:203]
    v_rcp_f32 v84, v84
    v_rcp_f32 v85, v85
    v_pk_mul_f32 v[152:153], v[152:153], v[216:217]
    v_rcp_f32 v86, v86
    v_rcp_f32 v87, v87
    v_pk_mul_f32 v[154:155], v[154:155], v[218:219]
    v_pk_mul_f32 v[136:137], v[136:137], v[80:81]
    v_pk_mul_f32 v[138:139], v[138:139], v[82:83]
    v_pk_mul_f32 v[152:153], v[152:153], v[84:85]
    v_pk_mul_f32 v[154:155], v[154:155], v[86:87]
    v_cvt_pk_bf16_f32 v64, v136, v137
    v_cvt_pk_bf16_f32 v65, v138, v139
    v_cvt_pk_bf16_f32 v66, v152, v153
    v_cvt_pk_bf16_f32 v67, v154, v155
    s_add_u32 s68, s84, 0
    buffer_store_dwordx4 v[64:67], v26, s[44:47], s68 offen sc1
    v_pk_fma_f32 v[168:169], v[40:41], v[20:21], v[168:169] op_sel_hi:[1,0,1] neg_lo:[0,1,0] neg_hi:[0,1,0]
    v_pk_fma_f32 v[170:171], v[42:43], v[20:21], v[170:171] op_sel_hi:[1,0,1] neg_lo:[0,1,0] neg_hi:[0,1,0]
    v_pk_fma_f32 v[184:185], v[44:45], v[20:21], v[184:185] op_sel_hi:[1,0,1] neg_lo:[0,1,0] neg_hi:[0,1,0]
    v_pk_fma_f32 v[186:187], v[46:47], v[20:21], v[186:187] op_sel_hi:[1,0,1] neg_lo:[0,1,0] neg_hi:[0,1,0]
    v_pk_mul_f32 v[168:169], v[168:169], v[20:21] op_sel:[0,1] op_sel_hi:[1,1]
    v_pk_mul_f32 v[170:171], v[170:171], v[20:21] op_sel:[0,1] op_sel_hi:[1,1]
    v_pk_mul_f32 v[184:185], v[184:185], v[20:21] op_sel:[0,1] op_sel_hi:[1,1]
    v_pk_mul_f32 v[186:187], v[186:187], v[20:21] op_sel:[0,1] op_sel_hi:[1,1]
    v_pk_mul_f32 v[80:81], v[168:169], v[168:169]
    v_pk_mul_f32 v[82:83], v[170:171], v[170:171]
    v_pk_mul_f32 v[84:85], v[184:185], v[184:185]
    v_pk_mul_f32 v[86:87], v[186:187], v[186:187]
    v_pk_fma_f32 v[80:81], v[80:81], v[8:9], s[86:87]
    v_pk_fma_f32 v[82:83], v[82:83], v[8:9], s[86:87]
    v_pk_fma_f32 v[84:85], v[84:85], v[8:9], s[86:87]
    v_pk_fma_f32 v[86:87], v[86:87], v[8:9], s[86:87]
    v_pk_mul_f32 v[80:81], v[80:81], v[168:169]
    v_pk_mul_f32 v[82:83], v[82:83], v[170:171]
    v_pk_mul_f32 v[84:85], v[84:85], v[184:185]
    v_pk_mul_f32 v[86:87], v[86:87], v[186:187]
    v_exp_f32 v80, v80
    v_exp_f32 v81, v81
    v_pk_fma_f32 v[232:233], v[56:57], v[20:21], v[232:233] op_sel_hi:[1,0,1] neg_lo:[0,1,0] neg_hi:[0,1,0]
    v_exp_f32 v82, v82
    v_exp_f32 v83, v83
    v_pk_fma_f32 v[234:235], v[58:59], v[20:21], v[234:235] op_sel_hi:[1,0,1] neg_lo:[0,1,0] neg_hi:[0,1,0]
    v_exp_f32 v84, v84
    v_exp_f32 v85, v85
    v_pk_fma_f32 v[248:249], v[60:61], v[20:21], v[248:249] op_sel_hi:[1,0,1] neg_lo:[0,1,0] neg_hi:[0,1,0]
    v_exp_f32 v86, v86
    v_exp_f32 v87, v87
    v_pk_fma_f32 v[250:251], v[62:63], v[20:21], v[250:251] op_sel_hi:[1,0,1] neg_lo:[0,1,0] neg_hi:[0,1,0]
    v_fma_f32 v80, v80, v12, v12
    v_fma_f32 v81, v81, v12, v12
    v_fma_f32 v82, v82, v12, v12
    v_fma_f32 v83, v83, v12, v12
    v_fma_f32 v84, v84, v12, v12
    v_fma_f32 v85, v85, v12, v12
    v_fma_f32 v86, v86, v12, v12
    v_fma_f32 v87, v87, v12, v12
    v_rcp_f32 v80, v80
    v_rcp_f32 v81, v81
    v_pk_mul_f32 v[168:169], v[168:169], v[232:233]
    v_rcp_f32 v82, v82
    v_rcp_f32 v83, v83
    v_pk_mul_f32 v[170:171], v[170:171], v[234:235]
    v_rcp_f32 v84, v84
    v_rcp_f32 v85, v85
    v_pk_mul_f32 v[184:185], v[184:185], v[248:249]
    v_rcp_f32 v86, v86
    v_rcp_f32 v87, v87
    v_pk_mul_f32 v[186:187], v[186:187], v[250:251]
    v_pk_mul_f32 v[168:169], v[168:169], v[80:81]
    v_pk_mul_f32 v[170:171], v[170:171], v[82:83]
    v_pk_mul_f32 v[184:185], v[184:185], v[84:85]
    v_pk_mul_f32 v[186:187], v[186:187], v[86:87]
    v_cvt_pk_bf16_f32 v68, v168, v169
    v_cvt_pk_bf16_f32 v69, v170, v171
    v_cvt_pk_bf16_f32 v70, v184, v185
    v_cvt_pk_bf16_f32 v71, v186, v187
    s_add_u32 s68, s84, 0
    buffer_store_dwordx4 v[68:71], v27, s[44:47], s68 offen sc1
    v_pk_fma_f32 v[140:141], v[32:33], v[22:23], v[140:141] op_sel_hi:[1,0,1] neg_lo:[0,1,0] neg_hi:[0,1,0]
    v_pk_fma_f32 v[142:143], v[34:35], v[22:23], v[142:143] op_sel_hi:[1,0,1] neg_lo:[0,1,0] neg_hi:[0,1,0]
    v_pk_fma_f32 v[156:157], v[36:37], v[22:23], v[156:157] op_sel_hi:[1,0,1] neg_lo:[0,1,0] neg_hi:[0,1,0]
    v_pk_fma_f32 v[158:159], v[38:39], v[22:23], v[158:159] op_sel_hi:[1,0,1] neg_lo:[0,1,0] neg_hi:[0,1,0]
    v_pk_mul_f32 v[140:141], v[140:141], v[22:23] op_sel:[0,1] op_sel_hi:[1,1]
    v_pk_mul_f32 v[142:143], v[142:143], v[22:23] op_sel:[0,1] op_sel_hi:[1,1]
    v_pk_mul_f32 v[156:157], v[156:157], v[22:23] op_sel:[0,1] op_sel_hi:[1,1]
    v_pk_mul_f32 v[158:159], v[158:159], v[22:23] op_sel:[0,1] op_sel_hi:[1,1]
    v_pk_mul_f32 v[80:81], v[140:141], v[140:141]
    v_pk_mul_f32 v[82:83], v[142:143], v[142:143]
    v_pk_mul_f32 v[84:85], v[156:157], v[156:157]
    v_pk_mul_f32 v[86:87], v[158:159], v[158:159]
    v_pk_fma_f32 v[80:81], v[80:81], v[8:9], s[86:87]
    v_pk_fma_f32 v[82:83], v[82:83], v[8:9], s[86:87]
    v_pk_fma_f32 v[84:85], v[84:85], v[8:9], s[86:87]
    v_pk_fma_f32 v[86:87], v[86:87], v[8:9], s[86:87]
    v_pk_mul_f32 v[80:81], v[80:81], v[140:141]
    v_pk_mul_f32 v[82:83], v[82:83], v[142:143]
    v_pk_mul_f32 v[84:85], v[84:85], v[156:157]
    v_pk_mul_f32 v[86:87], v[86:87], v[158:159]
    v_exp_f32 v80, v80
    v_exp_f32 v81, v81
    v_pk_fma_f32 v[204:205], v[48:49], v[22:23], v[204:205] op_sel_hi:[1,0,1] neg_lo:[0,1,0] neg_hi:[0,1,0]
    v_exp_f32 v82, v82
    v_exp_f32 v83, v83
    v_pk_fma_f32 v[206:207], v[50:51], v[22:23], v[206:207] op_sel_hi:[1,0,1] neg_lo:[0,1,0] neg_hi:[0,1,0]
    v_exp_f32 v84, v84
    v_exp_f32 v85, v85
    v_pk_fma_f32 v[220:221], v[52:53], v[22:23], v[220:221] op_sel_hi:[1,0,1] neg_lo:[0,1,0] neg_hi:[0,1,0]
    v_exp_f32 v86, v86
    v_exp_f32 v87, v87
    v_pk_fma_f32 v[222:223], v[54:55], v[22:23], v[222:223] op_sel_hi:[1,0,1] neg_lo:[0,1,0] neg_hi:[0,1,0]
    v_fma_f32 v80, v80, v13, v13
    v_fma_f32 v81, v81, v13, v13
    v_fma_f32 v82, v82, v13, v13
    v_fma_f32 v83, v83, v13, v13
    v_fma_f32 v84, v84, v13, v13
    v_fma_f32 v85, v85, v13, v13
    v_fma_f32 v86, v86, v13, v13
    v_fma_f32 v87, v87, v13, v13
    v_rcp_f32 v80, v80
    v_rcp_f32 v81, v81
    v_pk_mul_f32 v[140:141], v[140:141], v[204:205]
    v_rcp_f32 v82, v82
    v_rcp_f32 v83, v83
    v_pk_mul_f32 v[142:143], v[142:143], v[206:207]
    v_rcp_f32 v84, v84
    v_rcp_f32 v85, v85
    v_pk_mul_f32 v[156:157], v[156:157], v[220:221]
    v_rcp_f32 v86, v86
    v_rcp_f32 v87, v87
    v_pk_mul_f32 v[158:159], v[158:159], v[222:223]
    v_pk_mul_f32 v[140:141], v[140:141], v[80:81]
    v_pk_mul_f32 v[142:143], v[142:143], v[82:83]
    v_pk_mul_f32 v[156:157], v[156:157], v[84:85]
    v_pk_mul_f32 v[158:159], v[158:159], v[86:87]
    v_cvt_pk_bf16_f32 v64, v140, v141
    v_cvt_pk_bf16_f32 v65, v142, v143
    v_cvt_pk_bf16_f32 v66, v156, v157
    v_cvt_pk_bf16_f32 v67, v158, v159
    s_add_u32 s68, s84, 57344
    buffer_store_dwordx4 v[64:67], v26, s[44:47], s68 offen sc1
    v_pk_fma_f32 v[172:173], v[40:41], v[22:23], v[172:173] op_sel_hi:[1,0,1] neg_lo:[0,1,0] neg_hi:[0,1,0]
    v_pk_fma_f32 v[174:175], v[42:43], v[22:23], v[174:175] op_sel_hi:[1,0,1] neg_lo:[0,1,0] neg_hi:[0,1,0]
    v_pk_fma_f32 v[188:189], v[44:45], v[22:23], v[188:189] op_sel_hi:[1,0,1] neg_lo:[0,1,0] neg_hi:[0,1,0]
    v_pk_fma_f32 v[190:191], v[46:47], v[22:23], v[190:191] op_sel_hi:[1,0,1] neg_lo:[0,1,0] neg_hi:[0,1,0]
    v_pk_mul_f32 v[172:173], v[172:173], v[22:23] op_sel:[0,1] op_sel_hi:[1,1]
    v_pk_mul_f32 v[174:175], v[174:175], v[22:23] op_sel:[0,1] op_sel_hi:[1,1]
    v_pk_mul_f32 v[188:189], v[188:189], v[22:23] op_sel:[0,1] op_sel_hi:[1,1]
    v_pk_mul_f32 v[190:191], v[190:191], v[22:23] op_sel:[0,1] op_sel_hi:[1,1]
    v_pk_mul_f32 v[80:81], v[172:173], v[172:173]
    v_pk_mul_f32 v[82:83], v[174:175], v[174:175]
    v_pk_mul_f32 v[84:85], v[188:189], v[188:189]
    v_pk_mul_f32 v[86:87], v[190:191], v[190:191]
    v_pk_fma_f32 v[80:81], v[80:81], v[8:9], s[86:87]
    v_pk_fma_f32 v[82:83], v[82:83], v[8:9], s[86:87]
    v_pk_fma_f32 v[84:85], v[84:85], v[8:9], s[86:87]
    v_pk_fma_f32 v[86:87], v[86:87], v[8:9], s[86:87]
    v_pk_mul_f32 v[80:81], v[80:81], v[172:173]
    v_pk_mul_f32 v[82:83], v[82:83], v[174:175]
    v_pk_mul_f32 v[84:85], v[84:85], v[188:189]
    v_pk_mul_f32 v[86:87], v[86:87], v[190:191]
    v_exp_f32 v80, v80
    v_exp_f32 v81, v81
    v_pk_fma_f32 v[236:237], v[56:57], v[22:23], v[236:237] op_sel_hi:[1,0,1] neg_lo:[0,1,0] neg_hi:[0,1,0]
    v_exp_f32 v82, v82
    v_exp_f32 v83, v83
    v_pk_fma_f32 v[238:239], v[58:59], v[22:23], v[238:239] op_sel_hi:[1,0,1] neg_lo:[0,1,0] neg_hi:[0,1,0]
    v_exp_f32 v84, v84
    v_exp_f32 v85, v85
    v_pk_fma_f32 v[252:253], v[60:61], v[22:23], v[252:253] op_sel_hi:[1,0,1] neg_lo:[0,1,0] neg_hi:[0,1,0]
    v_exp_f32 v86, v86
    v_exp_f32 v87, v87
    v_pk_fma_f32 v[254:255], v[62:63], v[22:23], v[254:255] op_sel_hi:[1,0,1] neg_lo:[0,1,0] neg_hi:[0,1,0]
    v_fma_f32 v80, v80, v13, v13
    v_fma_f32 v81, v81, v13, v13
    v_fma_f32 v82, v82, v13, v13
    v_fma_f32 v83, v83, v13, v13
    v_fma_f32 v84, v84, v13, v13
    v_fma_f32 v85, v85, v13, v13
    v_fma_f32 v86, v86, v13, v13
    v_fma_f32 v87, v87, v13, v13
    v_rcp_f32 v80, v80
    v_rcp_f32 v81, v81
    v_pk_mul_f32 v[172:173], v[172:173], v[236:237]
    v_rcp_f32 v82, v82
    v_rcp_f32 v83, v83
    v_pk_mul_f32 v[174:175], v[174:175], v[238:239]
    v_rcp_f32 v84, v84
    v_rcp_f32 v85, v85
    v_pk_mul_f32 v[188:189], v[188:189], v[252:253]
    v_rcp_f32 v86, v86
    v_rcp_f32 v87, v87
    v_pk_mul_f32 v[190:191], v[190:191], v[254:255]
    v_pk_mul_f32 v[172:173], v[172:173], v[80:81]
    v_pk_mul_f32 v[174:175], v[174:175], v[82:83]
    v_pk_mul_f32 v[188:189], v[188:189], v[84:85]
    v_pk_mul_f32 v[190:191], v[190:191], v[86:87]
    v_cvt_pk_bf16_f32 v68, v172, v173
    v_cvt_pk_bf16_f32 v69, v174, v175
    v_cvt_pk_bf16_f32 v70, v188, v189
    v_cvt_pk_bf16_f32 v71, v190, v191
    s_add_u32 s68, s84, 57344
    buffer_store_dwordx4 v[68:71], v27, s[44:47], s68 offen sc1
    s_lshl_b32 s68, s8, 1
    s_add_u32 s68, s68, s10
    s_lshl_b32 s68, s68, 5
    s_lshl_b32 s69, s9, 1
    s_add_u32 s68, s68, s69
    s_add_u32 s68, s68, s11
    s_lshl_b32 s68, s68, 7
    s_add_u32 s85, s68, 13631488
    s_waitcnt vmcnt(0)
    v_mov_b32 v28, s6
    v_mov_b32 v29, s7
    s_mov_b64 exec, 1
    buffer_store_dwordx2 v[28:29], off, s[44:47], s85 sc1
    s_mov_b64 exec, -1
    s_barrier
    s_branch L_g2b
L_g2:
    s_barrier
    s_barrier
L_g2b:
    s_mov_b32 s92, s34
    s_and_b32 s93, s35, 0xffff
    s_mov_b32 s94, 1835008
    s_mov_b32 s95, 0x20000
    v_lshrrev_b32 v24, 3, v2
    v_bfe_u32 v25, v2, 1, 2
    v_xor_b32 v25, v25, v1
    v_lshlrev_b32 v24, 10, v24
    v_lshl_add_u32 v24, v25, 5, v24
    v_and_b32 v25, 1, v2
    v_lshl_add_u32 v24, v25, 4, v24
    s_and_b32 s83, s3, 3
    s_mul_i32 s82, s83, 458752
    s_lshl_b32 s68, s77, 7
    s_add_u32 s82, s82, s68
    s_lshl_b32 s83, s83, 12
    v_min_u32 v8, 6, v2
    v_lshlrev_b32 v8, 7, v8
    s_lshl_b32 s68, s76, 12
    s_mul_i32 s69, s3, 896
    s_add_u32 s68, s68, s69
    s_add_u32 s85, s68, 13631488
    v_lshlrev_b32 v27, 4, v2
    v_lshrrev_b32 v9, 2, v3
    v_lshl_add_u32 v9, v1, 2, v9
    v_bfe_u32 v10, v9, 1, 2
    v_lshlrev_b32 v9, 7, v9
    v_lshl_add_u32 v9, v10, 5, v9
    v_and_b32 v10, 3, v3
    v_lshl_add_u32 v9, v10, 3, v9
    v_xor_b32 v10, 0, v9
    v_add_u32 v10, s83, v10
    v_add_u32 v14, 65536, v10
    v_xor_b32 v11, 32, v9
    v_add_u32 v11, s83, v11
    v_add_u32 v15, 65536, v11
    v_xor_b32 v12, 64, v9
    v_add_u32 v12, s83, v12
    v_add_u32 v16, 65536, v12
    v_xor_b32 v13, 96, v9
    v_add_u32 v13, s83, v13
    v_add_u32 v17, 65536, v13
    s_mul_i32 s69, s76, 229376
    s_mul_i32 s86, s3, 14336
    s_add_u32 s86, s86, s69
    s_add_u32 s87, s86, 57344
    s_add_u32 s88, s86, 114688
    s_add_u32 s89, s86, 172032
    ds_read_b64_tr_b16 v[32:33], v14 offset:0
    ds_read_b64_tr_b16 v[34:35], v14 offset:2048
    ds_read_b64_tr_b16 v[36:37], v15 offset:0
    ds_read_b64_tr_b16 v[38:39], v15 offset:2048
    ds_read_b64_tr_b16 v[40:41], v16 offset:0
    ds_read_b64_tr_b16 v[42:43], v16 offset:2048
    ds_read_b64_tr_b16 v[44:45], v17 offset:0
    ds_read_b64_tr_b16 v[46:47], v17 offset:2048
    s_waitcnt lgkmcnt(0)
    s_add_u32 m0, s83, 65536
    s_add_u32 s68, s82, 196608
    buffer_load_dwordx4 v24, s[92:95], s68 offen  lds
    s_add_u32 m0, s83, 66560
    s_add_u32 s68, s82, 204800
    buffer_load_dwordx4 v24, s[92:95], s68 offen  lds
    s_add_u32 m0, s83, 67584
    s_add_u32 s68, s82, 212992
    buffer_load_dwordx4 v24, s[92:95], s68 offen  lds
    s_add_u32 m0, s83, 68608
    s_add_u32 s68, s82, 221184
    buffer_load_dwordx4 v24, s[92:95], s68 offen  lds
    ds_read_b64_tr_b16 v[48:49], v14 offset:16384
    ds_read_b64_tr_b16 v[50:51], v14 offset:18432
    ds_read_b64_tr_b16 v[52:53], v15 offset:16384
    ds_read_b64_tr_b16 v[54:55], v15 offset:18432
    ds_read_b64_tr_b16 v[56:57], v16 offset:16384
    ds_read_b64_tr_b16 v[58:59], v16 offset:18432
    ds_read_b64_tr_b16 v[60:61], v17 offset:16384
    ds_read_b64_tr_b16 v[62:63], v17 offset:18432
    s_waitcnt lgkmcnt(0)
    s_add_u32 m0, s83, 81920
    s_add_u32 s68, s82, 229376
    buffer_load_dwordx4 v24, s[92:95], s68 offen  lds
    s_add_u32 m0, s83, 82944
    s_add_u32 s68, s82, 237568
    buffer_load_dwordx4 v24, s[92:95], s68 offen  lds
    s_add_u32 m0, s83, 83968
    s_add_u32 s68, s82, 245760
    buffer_load_dwordx4 v24, s[92:95], s68 offen  lds
    s_add_u32 m0, s83, 84992
    s_add_u32 s68, s82, 253952
    buffer_load_dwordx4 v24, s[92:95], s68 offen  lds
    ds_read_b64_tr_b16 v[64:65], v10 offset:0
    ds_read_b64_tr_b16 v[66:67], v10 offset:2048
    ds_read_b64_tr_b16 v[68:69], v11 offset:0
    ds_read_b64_tr_b16 v[70:71], v11 offset:2048
    ds_read_b64_tr_b16 v[72:73], v12 offset:0
    ds_read_b64_tr_b16 v[74:75], v12 offset:2048
    ds_read_b64_tr_b16 v[76:77], v13 offset:0
    ds_read_b64_tr_b16 v[78:79], v13 offset:2048
    s_waitcnt lgkmcnt(0)
    s_add_u32 m0, s83, 0
    s_add_u32 s68, s82, 262144
    buffer_load_dwordx4 v24, s[92:95], s68 offen  lds
    s_add_u32 m0, s83, 1024
    s_add_u32 s68, s82, 270336
    buffer_load_dwordx4 v24, s[92:95], s68 offen  lds
    s_add_u32 m0, s83, 2048
    s_add_u32 s68, s82, 278528
    buffer_load_dwordx4 v24, s[92:95], s68 offen  lds
    s_add_u32 m0, s83, 3072
    s_add_u32 s68, s82, 286720
    buffer_load_dwordx4 v24, s[92:95], s68 offen  lds
    ds_read_b64_tr_b16 v[80:81], v10 offset:16384
    ds_read_b64_tr_b16 v[82:83], v10 offset:18432
    ds_read_b64_tr_b16 v[84:85], v11 offset:16384
    ds_read_b64_tr_b16 v[86:87], v11 offset:18432
    ds_read_b64_tr_b16 v[88:89], v12 offset:16384
    ds_read_b64_tr_b16 v[90:91], v12 offset:18432
    ds_read_b64_tr_b16 v[92:93], v13 offset:16384
    ds_read_b64_tr_b16 v[94:95], v13 offset:18432
    s_waitcnt lgkmcnt(0)
    s_add_u32 m0, s83, 16384
    s_add_u32 s68, s82, 294912
    buffer_load_dwordx4 v24, s[92:95], s68 offen  lds
    s_add_u32 m0, s83, 17408
    s_add_u32 s68, s82, 303104
    buffer_load_dwordx4 v24, s[92:95], s68 offen  lds
    s_add_u32 m0, s83, 18432
    s_add_u32 s68, s82, 311296
    buffer_load_dwordx4 v24, s[92:95], s68 offen  lds
    s_add_u32 m0, s83, 19456
    s_add_u32 s68, s82, 319488
    buffer_load_dwordx4 v24, s[92:95], s68 offen  lds
    ds_read_b64_tr_b16 v[96:97], v10 offset:32768
    ds_read_b64_tr_b16 v[98:99], v10 offset:34816
    ds_read_b64_tr_b16 v[100:101], v11 offset:32768
    ds_read_b64_tr_b16 v[102:103], v11 offset:34816
    ds_read_b64_tr_b16 v[104:105], v12 offset:32768
    ds_read_b64_tr_b16 v[106:107], v12 offset:34816
    ds_read_b64_tr_b16 v[108:109], v13 offset:32768
    ds_read_b64_tr_b16 v[110:111], v13 offset:34816
    s_waitcnt lgkmcnt(0)
    s_add_u32 m0, s83, 32768
    s_add_u32 s68, s82, 327680
    buffer_load_dwordx4 v24, s[92:95], s68 offen  lds
    s_add_u32 m0, s83, 33792
    s_add_u32 s68, s82, 335872
    buffer_load_dwordx4 v24, s[92:95], s68 offen  lds
    s_add_u32 m0, s83, 34816
    s_add_u32 s68, s82, 344064
    buffer_load_dwordx4 v24, s[92:95], s68 offen  lds
    s_add_u32 m0, s83, 35840
    s_add_u32 s68, s82, 352256
    buffer_load_dwordx4 v24, s[92:95], s68 offen  lds
    s_mov_b32 s52, s16
    s_and_b32 s53, s17, 0xffff
    s_mov_b32 s54, 2097152
    s_mov_b32 s55, 0x20000
    s_and_b32 s68, s3, 3
    s_lshl_b32 s68, s68, 14
    s_lshl_b32 s69, s76, 16
    s_add_u32 s68, s68, s69
    s_lshr_b32 s69, s3, 2
    s_lshl_b32 s69, s69, 6
    s_add_u32 s68, s68, s69
    s_lshl_b32 s69, s77, 7
    s_add_u32 s68, s68, s69
    v_lshlrev_b32 v26, 10, v3
    v_lshl_add_u32 v26, v1, 4, v26
    v_add_u32 v26, s68, v26
    buffer_load_dwordx4 v[4:7], v26, s[52:55], 0 offen
    buffer_load_dwordx2 v[28:29], v8, s[44:47], s85 offen sc1
    s_waitcnt vmcnt(0)
    s_mov_b32 s68, 200000
pl_5:
    v_cmp_ne_u64 vcc, s[6:7], v[28:29]
    s_cbranch_vccz pld_6
    s_sleep 4
    buffer_load_dwordx2 v[28:29], v8, s[44:47], s85 offen sc1
    s_sub_u32 s68, s68, 1
    s_cmp_lg_u32 s68, 0
    s_waitcnt vmcnt(0)
    s_cbranch_scc1 pl_5
pld_6:
    buffer_load_dwordx4 v[112:115], v27, s[44:47], s86 offen offset:0 sc1
    buffer_load_dwordx4 v[116:119], v27, s[44:47], s87 offen offset:0 sc1
    buffer_load_dwordx4 v[120:123], v27, s[44:47], s88 offen offset:0 sc1
    buffer_load_dwordx4 v[124:127], v27, s[44:47], s89 offen offset:0 sc1
    buffer_load_dwordx4 v[128:131], v27, s[44:47], s86 offen offset:1024 sc1
    buffer_load_dwordx4 v[132:135], v27, s[44:47], s87 offen offset:1024 sc1
    buffer_load_dwordx4 v[136:139], v27, s[44:47], s88 offen offset:1024 sc1
    buffer_load_dwordx4 v[140:143], v27, s[44:47], s89 offen offset:1024 sc1
    buffer_load_dwordx4 v[144:147], v27, s[44:47], s86 offen offset:2048 sc1
    buffer_load_dwordx4 v[148:151], v27, s[44:47], s87 offen offset:2048 sc1
    buffer_load_dwordx4 v[152:155], v27, s[44:47], s88 offen offset:2048 sc1
    buffer_load_dwordx4 v[156:159], v27, s[44:47], s89 offen offset:2048 sc1
    buffer_load_dwordx4 v[160:163], v27, s[44:47], s86 offen offset:3072 sc1
    buffer_load_dwordx4 v[164:167], v27, s[44:47], s87 offen offset:3072 sc1
    buffer_load_dwordx4 v[168:171], v27, s[44:47], s88 offen offset:3072 sc1
    buffer_load_dwordx4 v[172:175], v27, s[44:47], s89 offen offset:3072 sc1
    s_add_u32 s86, s86, 4096
    buffer_load_dwordx4 v[176:179], v27, s[44:47], s86 offen offset:0 sc1
    s_add_u32 s87, s87, 4096
    buffer_load_dwordx4 v[180:183], v27, s[44:47], s87 offen offset:0 sc1
    s_add_u32 s88, s88, 4096
    buffer_load_dwordx4 v[184:187], v27, s[44:47], s88 offen offset:0 sc1
    s_add_u32 s89, s89, 4096
    buffer_load_dwordx4 v[188:191], v27, s[44:47], s89 offen offset:0 sc1
    s_waitcnt vmcnt(16)
    v_mfma_f32_16x16x32_bf16 v[192:195], v[32:35], v[112:115], 0
    v_mfma_f32_16x16x32_bf16 v[196:199], v[32:35], v[116:119], 0
    v_mfma_f32_16x16x32_bf16 v[200:203], v[32:35], v[120:123], 0
    v_mfma_f32_16x16x32_bf16 v[204:207], v[32:35], v[124:127], 0
    v_mfma_f32_16x16x32_bf16 v[208:211], v[36:39], v[112:115], 0
    v_mfma_f32_16x16x32_bf16 v[212:215], v[36:39], v[116:119], 0
    v_mfma_f32_16x16x32_bf16 v[216:219], v[36:39], v[120:123], 0
    v_mfma_f32_16x16x32_bf16 v[220:223], v[36:39], v[124:127], 0
    v_mfma_f32_16x16x32_bf16 v[224:227], v[40:43], v[112:115], 0
    v_mfma_f32_16x16x32_bf16 v[228:231], v[40:43], v[116:119], 0
    v_mfma_f32_16x16x32_bf16 v[232:235], v[40:43], v[120:123], 0
    v_mfma_f32_16x16x32_bf16 v[236:239], v[40:43], v[124:127], 0
    v_mfma_f32_16x16x32_bf16 v[240:243], v[44:47], v[112:115], 0
    v_mfma_f32_16x16x32_bf16 v[244:247], v[44:47], v[116:119], 0
    v_mfma_f32_16x16x32_bf16 v[248:251], v[44:47], v[120:123], 0
    v_mfma_f32_16x16x32_bf16 v[252:255], v[44:47], v[124:127], 0
    s_waitcnt vmcnt(12)
    v_mfma_f32_16x16x32_bf16 v[192:195], v[48:51], v[128:131], v[192:195]
    buffer_load_dwordx4 v[112:115], v27, s[44:47], s86 offen offset:1024 sc1
    v_mfma_f32_16x16x32_bf16 v[196:199], v[48:51], v[132:135], v[196:199]
    buffer_load_dwordx4 v[116:119], v27, s[44:47], s87 offen offset:1024 sc1
    v_mfma_f32_16x16x32_bf16 v[200:203], v[48:51], v[136:139], v[200:203]
    buffer_load_dwordx4 v[120:123], v27, s[44:47], s88 offen offset:1024 sc1
    v_mfma_f32_16x16x32_bf16 v[204:207], v[48:51], v[140:143], v[204:207]
    buffer_load_dwordx4 v[124:127], v27, s[44:47], s89 offen offset:1024 sc1
    v_mfma_f32_16x16x32_bf16 v[208:211], v[52:55], v[128:131], v[208:211]
    buffer_load_dwordx4 v[32:35], v27, s[44:47], s86 offen offset:2048 sc1
    v_mfma_f32_16x16x32_bf16 v[212:215], v[52:55], v[132:135], v[212:215]
    buffer_load_dwordx4 v[36:39], v27, s[44:47], s87 offen offset:2048 sc1
    v_mfma_f32_16x16x32_bf16 v[216:219], v[52:55], v[136:139], v[216:219]
    buffer_load_dwordx4 v[40:43], v27, s[44:47], s88 offen offset:2048 sc1
    v_mfma_f32_16x16x32_bf16 v[220:223], v[52:55], v[140:143], v[220:223]
    buffer_load_dwordx4 v[44:47], v27, s[44:47], s89 offen offset:2048 sc1
    v_mfma_f32_16x16x32_bf16 v[224:227], v[56:59], v[128:131], v[224:227]
    v_mfma_f32_16x16x32_bf16 v[228:231], v[56:59], v[132:135], v[228:231]
    v_mfma_f32_16x16x32_bf16 v[232:235], v[56:59], v[136:139], v[232:235]
    v_mfma_f32_16x16x32_bf16 v[236:239], v[56:59], v[140:143], v[236:239]
    v_mfma_f32_16x16x32_bf16 v[240:243], v[60:63], v[128:131], v[240:243]
    v_mfma_f32_16x16x32_bf16 v[244:247], v[60:63], v[132:135], v[244:247]
    v_mfma_f32_16x16x32_bf16 v[248:251], v[60:63], v[136:139], v[248:251]
    v_mfma_f32_16x16x32_bf16 v[252:255], v[60:63], v[140:143], v[252:255]
    s_waitcnt vmcnt(16)
    v_mfma_f32_16x16x32_bf16 v[192:195], v[64:67], v[144:147], v[192:195]
    buffer_load_dwordx4 v[128:131], v27, s[44:47], s86 offen offset:3072 sc1
    v_mfma_f32_16x16x32_bf16 v[196:199], v[64:67], v[148:151], v[196:199]
    buffer_load_dwordx4 v[132:135], v27, s[44:47], s87 offen offset:3072 sc1
    v_mfma_f32_16x16x32_bf16 v[200:203], v[64:67], v[152:155], v[200:203]
    buffer_load_dwordx4 v[136:139], v27, s[44:47], s88 offen offset:3072 sc1
    v_mfma_f32_16x16x32_bf16 v[204:207], v[64:67], v[156:159], v[204:207]
    buffer_load_dwordx4 v[140:143], v27, s[44:47], s89 offen offset:3072 sc1
    v_mfma_f32_16x16x32_bf16 v[208:211], v[68:71], v[144:147], v[208:211]
    s_add_u32 s86, s86, 4096
    buffer_load_dwordx4 v[48:51], v27, s[44:47], s86 offen offset:0 sc1
    v_mfma_f32_16x16x32_bf16 v[212:215], v[68:71], v[148:151], v[212:215]
    s_add_u32 s87, s87, 4096
    buffer_load_dwordx4 v[52:55], v27, s[44:47], s87 offen offset:0 sc1
    v_mfma_f32_16x16x32_bf16 v[216:219], v[68:71], v[152:155], v[216:219]
    s_add_u32 s88, s88, 4096
    buffer_load_dwordx4 v[56:59], v27, s[44:47], s88 offen offset:0 sc1
    v_mfma_f32_16x16x32_bf16 v[220:223], v[68:71], v[156:159], v[220:223]
    s_add_u32 s89, s89, 4096
    buffer_load_dwordx4 v[60:63], v27, s[44:47], s89 offen offset:0 sc1
    v_mfma_f32_16x16x32_bf16 v[224:227], v[72:75], v[144:147], v[224:227]
    v_mfma_f32_16x16x32_bf16 v[228:231], v[72:75], v[148:151], v[228:231]
    v_mfma_f32_16x16x32_bf16 v[232:235], v[72:75], v[152:155], v[232:235]
    v_mfma_f32_16x16x32_bf16 v[236:239], v[72:75], v[156:159], v[236:239]
    v_mfma_f32_16x16x32_bf16 v[240:243], v[76:79], v[144:147], v[240:243]
    v_mfma_f32_16x16x32_bf16 v[244:247], v[76:79], v[148:151], v[244:247]
    v_mfma_f32_16x16x32_bf16 v[248:251], v[76:79], v[152:155], v[248:251]
    v_mfma_f32_16x16x32_bf16 v[252:255], v[76:79], v[156:159], v[252:255]
    s_waitcnt vmcnt(20)
    v_mfma_f32_16x16x32_bf16 v[192:195], v[80:83], v[160:163], v[192:195]
    buffer_load_dwordx4 v[144:147], v27, s[44:47], s86 offen offset:1024 sc1
    v_mfma_f32_16x16x32_bf16 v[196:199], v[80:83], v[164:167], v[196:199]
    buffer_load_dwordx4 v[148:151], v27, s[44:47], s87 offen offset:1024 sc1
    v_mfma_f32_16x16x32_bf16 v[200:203], v[80:83], v[168:171], v[200:203]
    buffer_load_dwordx4 v[152:155], v27, s[44:47], s88 offen offset:1024 sc1
    v_mfma_f32_16x16x32_bf16 v[204:207], v[80:83], v[172:175], v[204:207]
    buffer_load_dwordx4 v[156:159], v27, s[44:47], s89 offen offset:1024 sc1
    v_mfma_f32_16x16x32_bf16 v[208:211], v[84:87], v[160:163], v[208:211]
    buffer_load_dwordx4 v[64:67], v27, s[44:47], s86 offen offset:2048 sc1
    v_mfma_f32_16x16x32_bf16 v[212:215], v[84:87], v[164:167], v[212:215]
    buffer_load_dwordx4 v[68:71], v27, s[44:47], s87 offen offset:2048 sc1
    v_mfma_f32_16x16x32_bf16 v[216:219], v[84:87], v[168:171], v[216:219]
    buffer_load_dwordx4 v[72:75], v27, s[44:47], s88 offen offset:2048 sc1
    v_mfma_f32_16x16x32_bf16 v[220:223], v[84:87], v[172:175], v[220:223]
    buffer_load_dwordx4 v[76:79], v27, s[44:47], s89 offen offset:2048 sc1
    v_mfma_f32_16x16x32_bf16 v[224:227], v[88:91], v[160:163], v[224:227]
    v_mfma_f32_16x16x32_bf16 v[228:231], v[88:91], v[164:167], v[228:231]
    v_mfma_f32_16x16x32_bf16 v[232:235], v[88:91], v[168:171], v[232:235]
    v_mfma_f32_16x16x32_bf16 v[236:239], v[88:91], v[172:175], v[236:239]
    v_mfma_f32_16x16x32_bf16 v[240:243], v[92:95], v[160:163], v[240:243]
    v_mfma_f32_16x16x32_bf16 v[244:247], v[92:95], v[164:167], v[244:247]
    v_mfma_f32_16x16x32_bf16 v[248:251], v[92:95], v[168:171], v[248:251]
    v_mfma_f32_16x16x32_bf16 v[252:255], v[92:95], v[172:175], v[252:255]
    s_waitcnt vmcnt(24)
    v_mfma_f32_16x16x32_bf16 v[192:195], v[96:99], v[176:179], v[192:195]
    ds_read_b64_tr_b16 v[160:161], v10 offset:49152
    v_mfma_f32_16x16x32_bf16 v[196:199], v[96:99], v[180:183], v[196:199]
    ds_read_b64_tr_b16 v[162:163], v10 offset:51200
    v_mfma_f32_16x16x32_bf16 v[200:203], v[96:99], v[184:187], v[200:203]
    ds_read_b64_tr_b16 v[164:165], v11 offset:49152
    v_mfma_f32_16x16x32_bf16 v[204:207], v[96:99], v[188:191], v[204:207]
    ds_read_b64_tr_b16 v[166:167], v11 offset:51200
    v_mfma_f32_16x16x32_bf16 v[208:211], v[100:103], v[176:179], v[208:211]
    ds_read_b64_tr_b16 v[168:169], v12 offset:49152
    v_mfma_f32_16x16x32_bf16 v[212:215], v[100:103], v[180:183], v[212:215]
    ds_read_b64_tr_b16 v[170:171], v12 offset:51200
    v_mfma_f32_16x16x32_bf16 v[216:219], v[100:103], v[184:187], v[216:219]
    ds_read_b64_tr_b16 v[172:173], v13 offset:49152
    v_mfma_f32_16x16x32_bf16 v[220:223], v[100:103], v[188:191], v[220:223]
    ds_read_b64_tr_b16 v[174:175], v13 offset:51200
    v_mfma_f32_16x16x32_bf16 v[224:227], v[104:107], v[176:179], v[224:227]
    buffer_load_dwordx4 v[80:83], v27, s[44:47], s86 offen offset:3072 sc1
    v_mfma_f32_16x16x32_bf16 v[228:231], v[104:107], v[180:183], v[228:231]
    buffer_load_dwordx4 v[84:87], v27, s[44:47], s87 offen offset:3072 sc1
    v_mfma_f32_16x16x32_bf16 v[232:235], v[104:107], v[184:187], v[232:235]
    buffer_load_dwordx4 v[88:91], v27, s[44:47], s88 offen offset:3072 sc1
    v_mfma_f32_16x16x32_bf16 v[236:239], v[104:107], v[188:191], v[236:239]
    buffer_load_dwordx4 v[92:95], v27, s[44:47], s89 offen offset:3072 sc1
    v_mfma_f32_16x16x32_bf16 v[240:243], v[108:111], v[176:179], v[240:243]
    v_mfma_f32_16x16x32_bf16 v[244:247], v[108:111], v[180:183], v[244:247]
    v_mfma_f32_16x16x32_bf16 v[248:251], v[108:111], v[184:187], v[248:251]
    v_mfma_f32_16x16x32_bf16 v[252:255], v[108:111], v[188:191], v[252:255]
    s_waitcnt vmcnt(24)
    s_waitcnt lgkmcnt(0)
    v_mfma_f32_16x16x32_bf16 v[192:195], v[160:163], v[112:115], v[192:195]
    ds_read_b64_tr_b16 v[176:177], v14 offset:0
    v_mfma_f32_16x16x32_bf16 v[196:199], v[160:163], v[116:119], v[196:199]
    ds_read_b64_tr_b16 v[178:179], v14 offset:2048
    v_mfma_f32_16x16x32_bf16 v[200:203], v[160:163], v[120:123], v[200:203]
    ds_read_b64_tr_b16 v[180:181], v15 offset:0
    v_mfma_f32_16x16x32_bf16 v[204:207], v[160:163], v[124:127], v[204:207]
    ds_read_b64_tr_b16 v[182:183], v15 offset:2048
    v_mfma_f32_16x16x32_bf16 v[208:211], v[164:167], v[112:115], v[208:211]
    ds_read_b64_tr_b16 v[184:185], v16 offset:0
    v_mfma_f32_16x16x32_bf16 v[212:215], v[164:167], v[116:119], v[212:215]
    ds_read_b64_tr_b16 v[186:187], v16 offset:2048
    v_mfma_f32_16x16x32_bf16 v[216:219], v[164:167], v[120:123], v[216:219]
    ds_read_b64_tr_b16 v[188:189], v17 offset:0
    v_mfma_f32_16x16x32_bf16 v[220:223], v[164:167], v[124:127], v[220:223]
    ds_read_b64_tr_b16 v[190:191], v17 offset:2048
    v_mfma_f32_16x16x32_bf16 v[224:227], v[168:171], v[112:115], v[224:227]
    s_add_u32 s86, s86, 4096
    buffer_load_dwordx4 v[96:99], v27, s[44:47], s86 offen offset:0 sc1
    v_mfma_f32_16x16x32_bf16 v[228:231], v[168:171], v[116:119], v[228:231]
    s_add_u32 s87, s87, 4096
    buffer_load_dwordx4 v[100:103], v27, s[44:47], s87 offen offset:0 sc1
    v_mfma_f32_16x16x32_bf16 v[232:235], v[168:171], v[120:123], v[232:235]
    s_add_u32 s88, s88, 4096
    buffer_load_dwordx4 v[104:107], v27, s[44:47], s88 offen offset:0 sc1
    v_mfma_f32_16x16x32_bf16 v[236:239], v[168:171], v[124:127], v[236:239]
    s_add_u32 s89, s89, 4096
    buffer_load_dwordx4 v[108:111], v27, s[44:47], s89 offen offset:0 sc1
    v_mfma_f32_16x16x32_bf16 v[240:243], v[172:175], v[112:115], v[240:243]
    s_add_u32 m0, s83, 49152
    s_add_u32 s68, s82, 360448
    buffer_load_dwordx4 v24, s[92:95], s68 offen  lds
    v_mfma_f32_16x16x32_bf16 v[244:247], v[172:175], v[116:119], v[244:247]
    s_add_u32 m0, s83, 50176
    s_add_u32 s68, s82, 368640
    buffer_load_dwordx4 v24, s[92:95], s68 offen  lds
    v_mfma_f32_16x16x32_bf16 v[248:251], v[172:175], v[120:123], v[248:251]
    s_add_u32 m0, s83, 51200
    s_add_u32 s68, s82, 376832
    buffer_load_dwordx4 v24, s[92:95], s68 offen  lds
    v_mfma_f32_16x16x32_bf16 v[252:255], v[172:175], v[124:127], v[252:255]
    s_add_u32 m0, s83, 52224
    s_add_u32 s68, s82, 385024
    buffer_load_dwordx4 v24, s[92:95], s68 offen  lds
    s_waitcnt vmcnt(28)
    s_waitcnt lgkmcnt(0)
    v_mfma_f32_16x16x32_bf16 v[192:195], v[176:179], v[32:35], v[192:195]
    ds_read_b64_tr_b16 v[112:113], v14 offset:16384
    v_mfma_f32_16x16x32_bf16 v[196:199], v[176:179], v[36:39], v[196:199]
    ds_read_b64_tr_b16 v[114:115], v14 offset:18432
    v_mfma_f32_16x16x32_bf16 v[200:203], v[176:179], v[40:43], v[200:203]
    ds_read_b64_tr_b16 v[116:117], v15 offset:16384
    v_mfma_f32_16x16x32_bf16 v[204:207], v[176:179], v[44:47], v[204:207]
    ds_read_b64_tr_b16 v[118:119], v15 offset:18432
    v_mfma_f32_16x16x32_bf16 v[208:211], v[180:183], v[32:35], v[208:211]
    ds_read_b64_tr_b16 v[120:121], v16 offset:16384
    v_mfma_f32_16x16x32_bf16 v[212:215], v[180:183], v[36:39], v[212:215]
    ds_read_b64_tr_b16 v[122:123], v16 offset:18432
    v_mfma_f32_16x16x32_bf16 v[216:219], v[180:183], v[40:43], v[216:219]
    ds_read_b64_tr_b16 v[124:125], v17 offset:16384
    v_mfma_f32_16x16x32_bf16 v[220:223], v[180:183], v[44:47], v[220:223]
    ds_read_b64_tr_b16 v[126:127], v17 offset:18432
    v_mfma_f32_16x16x32_bf16 v[224:227], v[184:187], v[32:35], v[224:227]
    buffer_load_dwordx4 v[160:163], v27, s[44:47], s86 offen offset:1024 sc1
    v_mfma_f32_16x16x32_bf16 v[228:231], v[184:187], v[36:39], v[228:231]
    buffer_load_dwordx4 v[164:167], v27, s[44:47], s87 offen offset:1024 sc1
    v_mfma_f32_16x16x32_bf16 v[232:235], v[184:187], v[40:43], v[232:235]
    buffer_load_dwordx4 v[168:171], v27, s[44:47], s88 offen offset:1024 sc1
    v_mfma_f32_16x16x32_bf16 v[236:239], v[184:187], v[44:47], v[236:239]
    buffer_load_dwordx4 v[172:175], v27, s[44:47], s89 offen offset:1024 sc1
    v_mfma_f32_16x16x32_bf16 v[240:243], v[188:191], v[32:35], v[240:243]
    s_add_u32 m0, s83, 65536
    s_add_u32 s68, s82, 393216
    buffer_load_dwordx4 v24, s[92:95], s68 offen  lds
    v_mfma_f32_16x16x32_bf16 v[244:247], v[188:191], v[36:39], v[244:247]
    s_add_u32 m0, s83, 66560
    s_add_u32 s68, s82, 401408
    buffer_load_dwordx4 v24, s[92:95], s68 offen  lds
    v_mfma_f32_16x16x32_bf16 v[248:251], v[188:191], v[40:43], v[248:251]
    s_add_u32 m0, s83, 67584
    s_add_u32 s68, s82, 409600
    buffer_load_dwordx4 v24, s[92:95], s68 offen  lds
    v_mfma_f32_16x16x32_bf16 v[252:255], v[188:191], v[44:47], v[252:255]
    s_add_u32 m0, s83, 68608
    s_add_u32 s68, s82, 417792
    buffer_load_dwordx4 v24, s[92:95], s68 offen  lds
    s_waitcnt vmcnt(32)
    s_waitcnt lgkmcnt(0)
    v_mfma_f32_16x16x32_bf16 v[192:195], v[112:115], v[128:131], v[192:195]
    ds_read_b64_tr_b16 v[32:33], v10 offset:0
    v_mfma_f32_16x16x32_bf16 v[196:199], v[112:115], v[132:135], v[196:199]
    ds_read_b64_tr_b16 v[34:35], v10 offset:2048
    v_mfma_f32_16x16x32_bf16 v[200:203], v[112:115], v[136:139], v[200:203]
    ds_read_b64_tr_b16 v[36:37], v11 offset:0
    v_mfma_f32_16x16x32_bf16 v[204:207], v[112:115], v[140:143], v[204:207]
    ds_read_b64_tr_b16 v[38:39], v11 offset:2048
    v_mfma_f32_16x16x32_bf16 v[208:211], v[116:119], v[128:131], v[208:211]
    ds_read_b64_tr_b16 v[40:41], v12 offset:0
    v_mfma_f32_16x16x32_bf16 v[212:215], v[116:119], v[132:135], v[212:215]
    ds_read_b64_tr_b16 v[42:43], v12 offset:2048
    v_mfma_f32_16x16x32_bf16 v[216:219], v[116:119], v[136:139], v[216:219]
    ds_read_b64_tr_b16 v[44:45], v13 offset:0
    v_mfma_f32_16x16x32_bf16 v[220:223], v[116:119], v[140:143], v[220:223]
    ds_read_b64_tr_b16 v[46:47], v13 offset:2048
    v_mfma_f32_16x16x32_bf16 v[224:227], v[120:123], v[128:131], v[224:227]
    s_add_u32 m0, s83, 81920
    s_add_u32 s68, s82, 425984
    buffer_load_dwordx4 v24, s[92:95], s68 offen  lds
    v_mfma_f32_16x16x32_bf16 v[228:231], v[120:123], v[132:135], v[228:231]
    s_add_u32 m0, s83, 82944
    s_add_u32 s68, s82, 434176
    buffer_load_dwordx4 v24, s[92:95], s68 offen  lds
    v_mfma_f32_16x16x32_bf16 v[232:235], v[120:123], v[136:139], v[232:235]
    s_add_u32 m0, s83, 83968
    s_add_u32 s68, s82, 442368
    buffer_load_dwordx4 v24, s[92:95], s68 offen  lds
    v_mfma_f32_16x16x32_bf16 v[236:239], v[120:123], v[140:143], v[236:239]
    s_add_u32 m0, s83, 84992
    s_add_u32 s68, s82, 450560
    buffer_load_dwordx4 v24, s[92:95], s68 offen  lds
    v_mfma_f32_16x16x32_bf16 v[240:243], v[124:127], v[128:131], v[240:243]
    v_mfma_f32_16x16x32_bf16 v[244:247], v[124:127], v[132:135], v[244:247]
    v_mfma_f32_16x16x32_bf16 v[248:251], v[124:127], v[136:139], v[248:251]
    v_mfma_f32_16x16x32_bf16 v[252:255], v[124:127], v[140:143], v[252:255]
    s_waitcnt vmcnt(32)
    s_waitcnt lgkmcnt(0)
    v_mfma_f32_16x16x32_bf16 v[192:195], v[32:35], v[48:51], v[192:195]
    ds_read_b64_tr_b16 v[176:177], v10 offset:16384
    v_mfma_f32_16x16x32_bf16 v[196:199], v[32:35], v[52:55], v[196:199]
    ds_read_b64_tr_b16 v[178:179], v10 offset:18432
    v_mfma_f32_16x16x32_bf16 v[200:203], v[32:35], v[56:59], v[200:203]
    ds_read_b64_tr_b16 v[180:181], v11 offset:16384
    v_mfma_f32_16x16x32_bf16 v[204:207], v[32:35], v[60:63], v[204:207]
    ds_read_b64_tr_b16 v[182:183], v11 offset:18432
    v_mfma_f32_16x16x32_bf16 v[208:211], v[36:39], v[48:51], v[208:211]
    ds_read_b64_tr_b16 v[184:185], v12 offset:16384
    v_mfma_f32_16x16x32_bf16 v[212:215], v[36:39], v[52:55], v[212:215]
    ds_read_b64_tr_b16 v[186:187], v12 offset:18432
    v_mfma_f32_16x16x32_bf16 v[216:219], v[36:39], v[56:59], v[216:219]
    ds_read_b64_tr_b16 v[188:189], v13 offset:16384
    v_mfma_f32_16x16x32_bf16 v[220:223], v[36:39], v[60:63], v[220:223]
    ds_read_b64_tr_b16 v[190:191], v13 offset:18432
    v_mfma_f32_16x16x32_bf16 v[224:227], v[40:43], v[48:51], v[224:227]
    v_mfma_f32_16x16x32_bf16 v[228:231], v[40:43], v[52:55], v[228:231]
    v_mfma_f32_16x16x32_bf16 v[232:235], v[40:43], v[56:59], v[232:235]
    v_mfma_f32_16x16x32_bf16 v[236:239], v[40:43], v[60:63], v[236:239]
    v_mfma_f32_16x16x32_bf16 v[240:243], v[44:47], v[48:51], v[240:243]
    v_mfma_f32_16x16x32_bf16 v[244:247], v[44:47], v[52:55], v[244:247]
    v_mfma_f32_16x16x32_bf16 v[248:251], v[44:47], v[56:59], v[248:251]
    v_mfma_f32_16x16x32_bf16 v[252:255], v[44:47], v[60:63], v[252:255]
    s_waitcnt vmcnt(28)
    s_waitcnt lgkmcnt(0)
    v_mfma_f32_16x16x32_bf16 v[192:195], v[176:179], v[144:147], v[192:195]
    ds_read_b64_tr_b16 v[128:129], v10 offset:32768
    v_mfma_f32_16x16x32_bf16 v[196:199], v[176:179], v[148:151], v[196:199]
    ds_read_b64_tr_b16 v[130:131], v10 offset:34816
    v_mfma_f32_16x16x32_bf16 v[200:203], v[176:179], v[152:155], v[200:203]
    ds_read_b64_tr_b16 v[132:133], v11 offset:32768
    v_mfma_f32_16x16x32_bf16 v[204:207], v[176:179], v[156:159], v[204:207]
    ds_read_b64_tr_b16 v[134:135], v11 offset:34816
    v_mfma_f32_16x16x32_bf16 v[208:211], v[180:183], v[144:147], v[208:211]
    ds_read_b64_tr_b16 v[136:137], v12 offset:32768
    v_mfma_f32_16x16x32_bf16 v[212:215], v[180:183], v[148:151], v[212:215]
    ds_read_b64_tr_b16 v[138:139], v12 offset:34816
    v_mfma_f32_16x16x32_bf16 v[216:219], v[180:183], v[152:155], v[216:219]
    ds_read_b64_tr_b16 v[140:141], v13 offset:32768
    v_mfma_f32_16x16x32_bf16 v[220:223], v[180:183], v[156:159], v[220:223]
    ds_read_b64_tr_b16 v[142:143], v13 offset:34816
    v_mfma_f32_16x16x32_bf16 v[224:227], v[184:187], v[144:147], v[224:227]
    v_mfma_f32_16x16x32_bf16 v[228:231], v[184:187], v[148:151], v[228:231]
    v_mfma_f32_16x16x32_bf16 v[232:235], v[184:187], v[152:155], v[232:235]
    v_mfma_f32_16x16x32_bf16 v[236:239], v[184:187], v[156:159], v[236:239]
    v_mfma_f32_16x16x32_bf16 v[240:243], v[188:191], v[144:147], v[240:243]
    v_mfma_f32_16x16x32_bf16 v[244:247], v[188:191], v[148:151], v[244:247]
    v_mfma_f32_16x16x32_bf16 v[248:251], v[188:191], v[152:155], v[248:251]
    v_mfma_f32_16x16x32_bf16 v[252:255], v[188:191], v[156:159], v[252:255]
    s_waitcnt vmcnt(12)
    s_waitcnt lgkmcnt(0)
    v_mfma_f32_16x16x32_bf16 v[192:195], v[128:131], v[64:67], v[192:195]
    ds_read_b64_tr_b16 v[112:113], v10 offset:49152
    v_mfma_f32_16x16x32_bf16 v[196:199], v[128:131], v[68:71], v[196:199]
    ds_read_b64_tr_b16 v[114:115], v10 offset:51200
    v_mfma_f32_16x16x32_bf16 v[200:203], v[128:131], v[72:75], v[200:203]
    ds_read_b64_tr_b16 v[116:117], v11 offset:49152
    v_mfma_f32_16x16x32_bf16 v[204:207], v[128:131], v[76:79], v[204:207]
    ds_read_b64_tr_b16 v[118:119], v11 offset:51200
    v_mfma_f32_16x16x32_bf16 v[208:211], v[132:135], v[64:67], v[208:211]
    ds_read_b64_tr_b16 v[120:121], v12 offset:49152
    v_mfma_f32_16x16x32_bf16 v[212:215], v[132:135], v[68:71], v[212:215]
    ds_read_b64_tr_b16 v[122:123], v12 offset:51200
    v_mfma_f32_16x16x32_bf16 v[216:219], v[132:135], v[72:75], v[216:219]
    ds_read_b64_tr_b16 v[124:125], v13 offset:49152
    v_mfma_f32_16x16x32_bf16 v[220:223], v[132:135], v[76:79], v[220:223]
    ds_read_b64_tr_b16 v[126:127], v13 offset:51200
    v_mfma_f32_16x16x32_bf16 v[224:227], v[136:139], v[64:67], v[224:227]
    v_mfma_f32_16x16x32_bf16 v[228:231], v[136:139], v[68:71], v[228:231]
    v_mfma_f32_16x16x32_bf16 v[232:235], v[136:139], v[72:75], v[232:235]
    v_mfma_f32_16x16x32_bf16 v[236:239], v[136:139], v[76:79], v[236:239]
    v_mfma_f32_16x16x32_bf16 v[240:243], v[140:143], v[64:67], v[240:243]
    v_mfma_f32_16x16x32_bf16 v[244:247], v[140:143], v[68:71], v[244:247]
    v_mfma_f32_16x16x32_bf16 v[248:251], v[140:143], v[72:75], v[248:251]
    v_mfma_f32_16x16x32_bf16 v[252:255], v[140:143], v[76:79], v[252:255]
    s_waitcnt vmcnt(4)
    s_waitcnt lgkmcnt(0)
    v_mfma_f32_16x16x32_bf16 v[192:195], v[112:115], v[80:83], v[192:195]
    ds_read_b64_tr_b16 v[48:49], v14 offset:0
    v_mfma_f32_16x16x32_bf16 v[196:199], v[112:115], v[84:87], v[196:199]
    ds_read_b64_tr_b16 v[50:51], v14 offset:2048
    v_mfma_f32_16x16x32_bf16 v[200:203], v[112:115], v[88:91], v[200:203]
    ds_read_b64_tr_b16 v[52:53], v15 offset:0
    v_mfma_f32_16x16x32_bf16 v[204:207], v[112:115], v[92:95], v[204:207]
    ds_read_b64_tr_b16 v[54:55], v15 offset:2048
    v_mfma_f32_16x16x32_bf16 v[208:211], v[116:119], v[80:83], v[208:211]
    ds_read_b64_tr_b16 v[56:57], v16 offset:0
    v_mfma_f32_16x16x32_bf16 v[212:215], v[116:119], v[84:87], v[212:215]
    ds_read_b64_tr_b16 v[58:59], v16 offset:2048
    v_mfma_f32_16x16x32_bf16 v[216:219], v[116:119], v[88:91], v[216:219]
    ds_read_b64_tr_b16 v[60:61], v17 offset:0
    v_mfma_f32_16x16x32_bf16 v[220:223], v[116:119], v[92:95], v[220:223]
    ds_read_b64_tr_b16 v[62:63], v17 offset:2048
    v_mfma_f32_16x16x32_bf16 v[224:227], v[120:123], v[80:83], v[224:227]
    v_mfma_f32_16x16x32_bf16 v[228:231], v[120:123], v[84:87], v[228:231]
    v_mfma_f32_16x16x32_bf16 v[232:235], v[120:123], v[88:91], v[232:235]
    v_mfma_f32_16x16x32_bf16 v[236:239], v[120:123], v[92:95], v[236:239]
    v_mfma_f32_16x16x32_bf16 v[240:243], v[124:127], v[80:83], v[240:243]
    v_mfma_f32_16x16x32_bf16 v[244:247], v[124:127], v[84:87], v[244:247]
    v_mfma_f32_16x16x32_bf16 v[248:251], v[124:127], v[88:91], v[248:251]
    v_mfma_f32_16x16x32_bf16 v[252:255], v[124:127], v[92:95], v[252:255]
    s_waitcnt vmcnt(0)
    s_waitcnt lgkmcnt(0)
    v_mfma_f32_16x16x32_bf16 v[192:195], v[48:51], v[96:99], v[192:195]
    ds_read_b64_tr_b16 v[32:33], v14 offset:16384
    v_mfma_f32_16x16x32_bf16 v[196:199], v[48:51], v[100:103], v[196:199]
    ds_read_b64_tr_b16 v[34:35], v14 offset:18432
    v_mfma_f32_16x16x32_bf16 v[200:203], v[48:51], v[104:107], v[200:203]
    ds_read_b64_tr_b16 v[36:37], v15 offset:16384
    v_mfma_f32_16x16x32_bf16 v[204:207], v[48:51], v[108:111], v[204:207]
    ds_read_b64_tr_b16 v[38:39], v15 offset:18432
    v_mfma_f32_16x16x32_bf16 v[208:211], v[52:55], v[96:99], v[208:211]
    ds_read_b64_tr_b16 v[40:41], v16 offset:16384
    v_mfma_f32_16x16x32_bf16 v[212:215], v[52:55], v[100:103], v[212:215]
    ds_read_b64_tr_b16 v[42:43], v16 offset:18432
    v_mfma_f32_16x16x32_bf16 v[216:219], v[52:55], v[104:107], v[216:219]
    ds_read_b64_tr_b16 v[44:45], v17 offset:16384
    v_mfma_f32_16x16x32_bf16 v[220:223], v[52:55], v[108:111], v[220:223]
    ds_read_b64_tr_b16 v[46:47], v17 offset:18432
    v_mfma_f32_16x16x32_bf16 v[224:227], v[56:59], v[96:99], v[224:227]
    v_mfma_f32_16x16x32_bf16 v[228:231], v[56:59], v[100:103], v[228:231]
    v_mfma_f32_16x16x32_bf16 v[232:235], v[56:59], v[104:107], v[232:235]
    v_mfma_f32_16x16x32_bf16 v[236:239], v[56:59], v[108:111], v[236:239]
    v_mfma_f32_16x16x32_bf16 v[240:243], v[60:63], v[96:99], v[240:243]
    v_mfma_f32_16x16x32_bf16 v[244:247], v[60:63], v[100:103], v[244:247]
    v_mfma_f32_16x16x32_bf16 v[248:251], v[60:63], v[104:107], v[248:251]
    v_mfma_f32_16x16x32_bf16 v[252:255], v[60:63], v[108:111], v[252:255]
    s_waitcnt lgkmcnt(0)
    v_mfma_f32_16x16x32_bf16 v[192:195], v[32:35], v[160:163], v[192:195]
    v_mfma_f32_16x16x32_bf16 v[196:199], v[32:35], v[164:167], v[196:199]
    v_mfma_f32_16x16x32_bf16 v[200:203], v[32:35], v[168:171], v[200:203]
    v_mfma_f32_16x16x32_bf16 v[204:207], v[32:35], v[172:175], v[204:207]
    v_mfma_f32_16x16x32_bf16 v[208:211], v[36:39], v[160:163], v[208:211]
    v_mfma_f32_16x16x32_bf16 v[212:215], v[36:39], v[164:167], v[212:215]
    v_mfma_f32_16x16x32_bf16 v[216:219], v[36:39], v[168:171], v[216:219]
    v_mfma_f32_16x16x32_bf16 v[220:223], v[36:39], v[172:175], v[220:223]
    v_mfma_f32_16x16x32_bf16 v[224:227], v[40:43], v[160:163], v[224:227]
    v_mfma_f32_16x16x32_bf16 v[228:231], v[40:43], v[164:167], v[228:231]
    v_mfma_f32_16x16x32_bf16 v[232:235], v[40:43], v[168:171], v[232:235]
    v_mfma_f32_16x16x32_bf16 v[236:239], v[40:43], v[172:175], v[236:239]
    v_mfma_f32_16x16x32_bf16 v[240:243], v[44:47], v[160:163], v[240:243]
    v_mfma_f32_16x16x32_bf16 v[244:247], v[44:47], v[164:167], v[244:247]
    v_mfma_f32_16x16x32_bf16 v[248:251], v[44:47], v[168:171], v[248:251]
    v_mfma_f32_16x16x32_bf16 v[252:255], v[44:47], v[172:175], v[252:255]
    v_xor_b32 v9, v1, v3
    v_lshlrev_b32 v9, 4, v9
    v_lshl_add_u32 v9, v3, 8, v9
    v_add_u32 v9, s83, v9
    v_xor_b32 v10, 64, v9
    v_xor_b32 v11, 128, v9
    v_xor_b32 v12, 192, v9
    s_nop 4
    ds_write_b128 v9, v[192:195] offset:0
    ds_write_b128 v9, v[196:199] offset:16384
    ds_write_b128 v9, v[200:203] offset:32768
    ds_write_b128 v9, v[204:207] offset:49152
    ds_write_b128 v10, v[208:211] offset:0
    ds_write_b128 v10, v[212:215] offset:16384
    ds_write_b128 v10, v[216:219] offset:32768
    ds_write_b128 v10, v[220:223] offset:49152
    ds_write_b128 v11, v[224:227] offset:0
    ds_write_b128 v11, v[228:231] offset:16384
    ds_write_b128 v11, v[232:235] offset:32768
    ds_write_b128 v11, v[236:239] offset:49152
    ds_write_b128 v12, v[240:243] offset:0
    ds_write_b128 v12, v[244:247] offset:16384
    ds_write_b128 v12, v[248:251] offset:32768
    ds_write_b128 v12, v[252:255] offset:49152
    s_branch L_fin
L_ph2aux:
    s_barrier
L_ph2b:
    s_bfe_u32 s68, s3, 0x10001
    s_mul_i32 s68, s68, 21248
    s_add_u32 s82, s68, 98304
    s_lshl_b32 s68, s90, 11
    s_add_u32 s68, s68, s82
    v_lshl_add_u32 v9, v2, 4, s68
    v_mov_b32 v12, 0
    v_mov_b32 v13, 0
    v_lshl_add_u32 v10, v2, 3, s82
    ds_write_b64 v10, v[12:13] offset:16640
    s_cmp_lg_u32 s90, 0
    s_cbranch_scc1 L_nohead
    v_readfirstlane_b32 s68, v64
    v_readfirstlane_b32 s69, v65
    v_and_b32 v10, 3, v2
    v_lshlrev_b32 v11, 4, v10
    v_sub_u32 v11, 48, v11
    v_mul_u32_u24 v10, 4160, v10
    v_add_u32 v10, s82, v10
    v_lshlrev_b64 v[14:15], v11, s[68:69]
    v_lshlrev_b64 v[14:15], 16, v[14:15]
    ds_write_b64 v10, v[12:13]
    ds_write_b64 v10, v[12:13] offset:8
    ds_write_b128 v10, v[12:15] offset:16
    s_branch L_head
L_nohead:
    v_mov_b32 v112, 0
L_head:
    v_alignbit_b32 v16, v68, v64, 16
    v_alignbit_b32 v20, v72, v68, 16
    v_alignbit_b32 v17, v69, v65, 16
    v_alignbit_b32 v21, v73, v69, 16
    v_alignbit_b32 v18, v70, v66, 16
    v_alignbit_b32 v22, v74, v70, 16
    v_alignbit_b32 v19, v71, v67, 16
    v_alignbit_b32 v23, v75, v71, 16
    ds_write_b128 v9, v[64:67] offset:32
    ds_write_b128 v9, v[16:19] offset:4192
    ds_write_b128 v9, v[68:71] offset:8352
    ds_write_b128 v9, v[20:23] offset:12512
    s_nop 0
    v_alignbit_b32 v16, v80, v76, 16
    v_alignbit_b32 v20, v84, v80, 16
    v_alignbit_b32 v17, v81, v77, 16
    v_alignbit_b32 v21, v85, v81, 16
    v_alignbit_b32 v18, v82, v78, 16
    v_alignbit_b32 v22, v86, v82, 16
    v_alignbit_b32 v19, v83, v79, 16
    v_alignbit_b32 v23, v87, v83, 16
    ds_write_b128 v9, v[76:79] offset:1056
    ds_write_b128 v9, v[16:19] offset:5216
    ds_write_b128 v9, v[80:83] offset:9376
    ds_write_b128 v9, v[20:23] offset:13536
    s_nop 0
    v_lshlrev_b32 v8, 3, v2
    v_add_u32 v8, 162304, v8
    ds_write_b64 v8, v[122:123]
    ds_write_b128 v9, v[114:117] offset:17152
    ds_write_b128 v9, v[118:121] offset:18176
    s_mov_b32 s52, s16
    s_and_b32 s53, s17, 0xffff
    s_mov_b32 s54, 2097152
    s_mov_b32 s55, 0x20000
    s_and_b32 s68, s3, 3
    s_lshl_b32 s68, s68, 14
    s_lshl_b32 s69, s76, 16
    s_add_u32 s68, s68, s69
    s_lshr_b32 s69, s3, 2
    s_lshl_b32 s69, s69, 6
    s_add_u32 s68, s68, s69
    s_lshl_b32 s69, s77, 7
    s_add_u32 s68, s68, s69
    v_lshlrev_b32 v26, 10, v3
    v_lshl_add_u32 v26, v1, 4, v26
    v_add_u32 v26, s68, v26
    buffer_load_dwordx4 v[4:7], v26, s[52:55], 0 offen
    v_add_u32 v10, 1, v3
    v_and_b32 v11, 3, v10
    v_mul_u32_u24 v11, 4160, v11
    v_lshrrev_b32 v10, 2, v10
    v_lshl_add_u32 v10, v10, 3, v11
    v_lshl_add_u32 v10, v1, 4, v10
    s_lshl_b32 s69, s90, 8
    s_add_u32 s68, s82, s69
    v_add_u32 v10, s68, v10
    v_add_u32 v11, 2048, v10
    v_lshlrev_b32 v12, 5, v3
    v_lshlrev_b32 v13, 4, v1
    v_sub_u32 v12, v12, v13
    s_add_u32 s68, s82, 17168
    s_sub_u32 s68, s68, s69
    v_add_u32 v12, s68, v12
    v_lshl_add_u32 v13, v1, 3, v3
    v_sub_u32 v13, 15, v13
    v_and_b32 v14, 1, v13
    v_lshlrev_b32 v14, 4, v14
    v_lshlrev_b32 v14, v14, v112
    v_ashrrev_i32 v13, 1, v13
    v_cmp_eq_u32 vcc, 0, v13
    v_cndmask_b32 v16, 0, v14, vcc
    v_cmp_eq_u32 vcc, 1, v13
    v_cndmask_b32 v17, 0, v14, vcc
    v_cmp_eq_u32 vcc, 2, v13
    v_cndmask_b32 v18, 0, v14, vcc
    v_cmp_eq_u32 vcc, 3, v13
    v_cndmask_b32 v19, 0, v14, vcc
    s_waitcnt vmcnt(0) lgkmcnt(0)
    s_barrier
    ds_read_b128 v[64:67], v12 offset:0
    ds_read_b64 v[32:33], v10 offset:0
    ds_read_b64 v[34:35], v10 offset:8
    ds_read_b128 v[68:71], v12 offset:512
    ds_read_b64 v[36:37], v10 offset:512
    ds_read_b64 v[38:39], v10 offset:520
    ds_read_b128 v[72:75], v12 offset:1024
    ds_read_b64 v[40:41], v10 offset:1024
    ds_read_b64 v[42:43], v10 offset:1032
    ds_read_b128 v[76:79], v12 offset:1536
    ds_read_b64 v[44:45], v10 offset:1536
    ds_read_b64 v[46:47], v10 offset:1544
    ds_read_b128 v[80:83], v12 offset:2048
    ds_read_b64 v[48:49], v10 offset:2048
    ds_read_b64 v[50:51], v10 offset:2056
    ds_read_b128 v[84:87], v12 offset:2560
    ds_read_b64 v[52:53], v10 offset:2560
    ds_read_b64 v[54:55], v10 offset:2568
    ds_read_b128 v[88:91], v12 offset:3072
    ds_read_b64 v[56:57], v10 offset:3072
    ds_read_b64 v[58:59], v10 offset:3080
    ds_read_b128 v[92:95], v12 offset:3584
    ds_read_b64 v[60:61], v10 offset:3584
    ds_read_b64 v[62:63], v10 offset:3592
    s_mov_b32 s83, 0
    s_waitcnt lgkmcnt(0)
    v_mfma_f32_16x16x32_bf16 v[128:131], v[16:19], v[64:67], 0
    v_mfma_f32_16x16x32_bf16 v[132:135], v[16:19], v[68:71], 0
    v_mfma_f32_16x16x32_bf16 v[136:139], v[16:19], v[72:75], 0
    v_mfma_f32_16x16x32_bf16 v[140:143], v[16:19], v[76:79], 0
    v_mfma_f32_16x16x32_bf16 v[144:147], v[16:19], v[80:83], 0
    v_mfma_f32_16x16x32_bf16 v[148:151], v[16:19], v[84:87], 0
    v_mfma_f32_16x16x32_bf16 v[152:155], v[16:19], v[88:91], 0
    v_mfma_f32_16x16x32_bf16 v[156:159], v[16:19], v[92:95], 0
L_cvloop:
    v_add_u32 v10, 64, v10
    v_add_u32 v11, 64, v11
    v_subrev_u32 v12, 64, v12
    s_waitcnt lgkmcnt(0)
    v_mfma_f32_16x16x32_bf16 v[128:131], v[32:35], v[64:67], v[128:131]
    ds_read_b128 v[192:195], v12 offset:0
    v_mfma_f32_16x16x32_bf16 v[132:135], v[32:35], v[68:71], v[132:135]
    ds_read_b64 v[160:161], v10 offset:0
    v_mfma_f32_16x16x32_bf16 v[136:139], v[32:35], v[72:75], v[136:139]
    ds_read_b64 v[162:163], v10 offset:8
    v_mfma_f32_16x16x32_bf16 v[140:143], v[32:35], v[76:79], v[140:143]
    ds_read_b128 v[196:199], v12 offset:512
    v_mfma_f32_16x16x32_bf16 v[144:147], v[32:35], v[80:83], v[144:147]
    ds_read_b64 v[164:165], v10 offset:512
    v_mfma_f32_16x16x32_bf16 v[148:151], v[32:35], v[84:87], v[148:151]
    ds_read_b64 v[166:167], v10 offset:520
    v_mfma_f32_16x16x32_bf16 v[152:155], v[32:35], v[88:91], v[152:155]
    ds_read_b128 v[200:203], v12 offset:1024
    v_mfma_f32_16x16x32_bf16 v[156:159], v[32:35], v[92:95], v[156:159]
    ds_read_b64 v[168:169], v10 offset:1024
    v_mfma_f32_16x16x32_bf16 v[132:135], v[36:39], v[64:67], v[132:135]
    ds_read_b64 v[170:171], v10 offset:1032
    v_mfma_f32_16x16x32_bf16 v[136:139], v[36:39], v[68:71], v[136:139]
    ds_read_b128 v[204:207], v12 offset:1536
    v_mfma_f32_16x16x32_bf16 v[140:143], v[36:39], v[72:75], v[140:143]
    ds_read_b64 v[172:173], v10 offset:1536
    v_mfma_f32_16x16x32_bf16 v[144:147], v[36:39], v[76:79], v[144:147]
    ds_read_b64 v[174:175], v10 offset:1544
    v_mfma_f32_16x16x32_bf16 v[148:151], v[36:39], v[80:83], v[148:151]
    ds_read_b128 v[208:211], v12 offset:2048
    v_mfma_f32_16x16x32_bf16 v[152:155], v[36:39], v[84:87], v[152:155]
    ds_read_b64 v[176:177], v10 offset:2048
    v_mfma_f32_16x16x32_bf16 v[156:159], v[36:39], v[88:91], v[156:159]
    ds_read_b64 v[178:179], v10 offset:2056
    v_mfma_f32_16x16x32_bf16 v[136:139], v[40:43], v[64:67], v[136:139]
    ds_read_b128 v[212:215], v12 offset:2560
    v_mfma_f32_16x16x32_bf16 v[140:143], v[40:43], v[68:71], v[140:143]
    ds_read_b64 v[180:181], v10 offset:2560
    v_mfma_f32_16x16x32_bf16 v[144:147], v[40:43], v[72:75], v[144:147]
    ds_read_b64 v[182:183], v10 offset:2568
    v_mfma_f32_16x16x32_bf16 v[148:151], v[40:43], v[76:79], v[148:151]
    ds_read_b128 v[216:219], v12 offset:3072
    v_mfma_f32_16x16x32_bf16 v[152:155], v[40:43], v[80:83], v[152:155]
    ds_read_b64 v[184:185], v10 offset:3072
    v_mfma_f32_16x16x32_bf16 v[156:159], v[40:43], v[84:87], v[156:159]
    ds_read_b64 v[186:187], v10 offset:3080
    v_mfma_f32_16x16x32_bf16 v[140:143], v[44:47], v[64:67], v[140:143]
    ds_read_b128 v[220:223], v12 offset:3584
    v_mfma_f32_16x16x32_bf16 v[144:147], v[44:47], v[68:71], v[144:147]
    ds_read_b64 v[188:189], v10 offset:3584
    v_mfma_f32_16x16x32_bf16 v[148:151], v[44:47], v[72:75], v[148:151]
    ds_read_b64 v[190:191], v10 offset:3592
    v_mfma_f32_16x16x32_bf16 v[152:155], v[44:47], v[76:79], v[152:155]
    v_mfma_f32_16x16x32_bf16 v[156:159], v[44:47], v[80:83], v[156:159]
    v_mfma_f32_16x16x32_bf16 v[144:147], v[48:51], v[64:67], v[144:147]
    v_mfma_f32_16x16x32_bf16 v[148:151], v[48:51], v[68:71], v[148:151]
    v_mfma_f32_16x16x32_bf16 v[152:155], v[48:51], v[72:75], v[152:155]
    v_mfma_f32_16x16x32_bf16 v[156:159], v[48:51], v[76:79], v[156:159]
    v_mfma_f32_16x16x32_bf16 v[148:151], v[52:55], v[64:67], v[148:151]
    v_mfma_f32_16x16x32_bf16 v[152:155], v[52:55], v[68:71], v[152:155]
    v_mfma_f32_16x16x32_bf16 v[156:159], v[52:55], v[72:75], v[156:159]
    v_mfma_f32_16x16x32_bf16 v[152:155], v[56:59], v[64:67], v[152:155]
    v_mfma_f32_16x16x32_bf16 v[156:159], v[56:59], v[68:71], v[156:159]
    v_mfma_f32_16x16x32_bf16 v[156:159], v[60:63], v[64:67], v[156:159]
    v_add_u32 v10, 64, v10
    v_add_u32 v11, 64, v11
    v_subrev_u32 v12, 64, v12
    s_waitcnt lgkmcnt(0)
    v_mfma_f32_16x16x32_bf16 v[128:131], v[160:163], v[192:195], v[128:131]
    ds_read_b128 v[64:67], v12 offset:0
    v_mfma_f32_16x16x32_bf16 v[132:135], v[160:163], v[196:199], v[132:135]
    ds_read_b64 v[32:33], v10 offset:0
    v_mfma_f32_16x16x32_bf16 v[136:139], v[160:163], v[200:203], v[136:139]
    ds_read_b64 v[34:35], v10 offset:8
    v_mfma_f32_16x16x32_bf16 v[140:143], v[160:163], v[204:207], v[140:143]
    ds_read_b128 v[68:71], v12 offset:512
    v_mfma_f32_16x16x32_bf16 v[144:147], v[160:163], v[208:211], v[144:147]
    ds_read_b64 v[36:37], v10 offset:512
    v_mfma_f32_16x16x32_bf16 v[148:151], v[160:163], v[212:215], v[148:151]
    ds_read_b64 v[38:39], v10 offset:520
    v_mfma_f32_16x16x32_bf16 v[152:155], v[160:163], v[216:219], v[152:155]
    ds_read_b128 v[72:75], v12 offset:1024
    v_mfma_f32_16x16x32_bf16 v[156:159], v[160:163], v[220:223], v[156:159]
    ds_read_b64 v[40:41], v10 offset:1024
    v_mfma_f32_16x16x32_bf16 v[132:135], v[164:167], v[192:195], v[132:135]
    ds_read_b64 v[42:43], v10 offset:1032
    v_mfma_f32_16x16x32_bf16 v[136:139], v[164:167], v[196:199], v[136:139]
    ds_read_b128 v[76:79], v12 offset:1536
    v_mfma_f32_16x16x32_bf16 v[140:143], v[164:167], v[200:203], v[140:143]
    ds_read_b64 v[44:45], v10 offset:1536
    v_mfma_f32_16x16x32_bf16 v[144:147], v[164:167], v[204:207], v[144:147]
    ds_read_b64 v[46:47], v10 offset:1544
    v_mfma_f32_16x16x32_bf16 v[148:151], v[164:167], v[208:211], v[148:151]
    ds_read_b128 v[80:83], v12 offset:2048
    v_mfma_f32_16x16x32_bf16 v[152:155], v[164:167], v[212:215], v[152:155]
    ds_read_b64 v[48:49], v10 offset:2048
    v_mfma_f32_16x16x32_bf16 v[156:159], v[164:167], v[216:219], v[156:159]
    ds_read_b64 v[50:51], v10 offset:2056
    v_mfma_f32_16x16x32_bf16 v[136:139], v[168:171], v[192:195], v[136:139]
    ds_read_b128 v[84:87], v12 offset:2560
    v_mfma_f32_16x16x32_bf16 v[140:143], v[168:171], v[196:199], v[140:143]
    ds_read_b64 v[52:53], v10 offset:2560
    v_mfma_f32_16x16x32_bf16 v[144:147], v[168:171], v[200:203], v[144:147]
    ds_read_b64 v[54:55], v10 offset:2568
    v_mfma_f32_16x16x32_bf16 v[148:151], v[168:171], v[204:207], v[148:151]
    ds_read_b128 v[88:91], v12 offset:3072
    v_mfma_f32_16x16x32_bf16 v[152:155], v[168:171], v[208:211], v[152:155]
    ds_read_b64 v[56:57], v10 offset:3072
    v_mfma_f32_16x16x32_bf16 v[156:159], v[168:171], v[212:215], v[156:159]
    ds_read_b64 v[58:59], v10 offset:3080
    v_mfma_f32_16x16x32_bf16 v[140:143], v[172:175], v[192:195], v[140:143]
    ds_read_b128 v[92:95], v12 offset:3584
    v_mfma_f32_16x16x32_bf16 v[144:147], v[172:175], v[196:199], v[144:147]
    ds_read_b64 v[60:61], v10 offset:3584
    v_mfma_f32_16x16x32_bf16 v[148:151], v[172:175], v[200:203], v[148:151]
    ds_read_b64 v[62:63], v10 offset:3592
    v_mfma_f32_16x16x32_bf16 v[152:155], v[172:175], v[204:207], v[152:155]
    v_mfma_f32_16x16x32_bf16 v[156:159], v[172:175], v[208:211], v[156:159]
    v_mfma_f32_16x16x32_bf16 v[144:147], v[176:179], v[192:195], v[144:147]
    v_mfma_f32_16x16x32_bf16 v[148:151], v[176:179], v[196:199], v[148:151]
    v_mfma_f32_16x16x32_bf16 v[152:155], v[176:179], v[200:203], v[152:155]
    v_mfma_f32_16x16x32_bf16 v[156:159], v[176:179], v[204:207], v[156:159]
    v_mfma_f32_16x16x32_bf16 v[148:151], v[180:183], v[192:195], v[148:151]
    v_mfma_f32_16x16x32_bf16 v[152:155], v[180:183], v[196:199], v[152:155]
    v_mfma_f32_16x16x32_bf16 v[156:159], v[180:183], v[200:203], v[156:159]
    v_mfma_f32_16x16x32_bf16 v[152:155], v[184:187], v[192:195], v[152:155]
    v_mfma_f32_16x16x32_bf16 v[156:159], v[184:187], v[196:199], v[156:159]
    v_mfma_f32_16x16x32_bf16 v[156:159], v[188:191], v[192:195], v[156:159]
    s_add_u32 s83, s83, 1
    s_cmp_lt_u32 s83, 2
    s_cbranch_scc1 L_cvloop
    s_lshl_b32 s84, s3, 12
    s_add_u32 s84, s84, 124416
    v_lshl_add_u32 v9, v2, 4, s84
    v_xor_b32 v10, 4096, v9
    s_lshl_b32 s68, s3, 2
    s_add_u32 s68, s68, 162816
    v_mov_b32 v11, s68
    v_xor_b32 v12, 4, v11
    s_cmp_eq_u32 s90, 0
    s_cbranch_scc1 L_noswap
    v_swap_b32 v128, v144
    v_swap_b32 v129, v145
    v_swap_b32 v130, v146
    v_swap_b32 v131, v147
    v_swap_b32 v132, v148
    v_swap_b32 v133, v149
    v_swap_b32 v134, v150
    v_swap_b32 v135, v151
    v_swap_b32 v136, v152
    v_swap_b32 v137, v153
    v_swap_b32 v138, v154
    v_swap_b32 v139, v155
    v_swap_b32 v140, v156
    v_swap_b32 v141, v157
    v_swap_b32 v142, v158
    v_swap_b32 v143, v159
L_noswap:
    ds_write_b128 v10, v[144:147] offset:0
    ds_write_b128 v10, v[148:151] offset:1024
    ds_write_b128 v10, v[152:155] offset:2048
    ds_write_b128 v10, v[156:159] offset:3072
    s_waitcnt lgkmcnt(0)
    ds_write_b32 v12, v11
    s_mov_b32 s68, 200000
L_pair:
    ds_read_b32 v13, v11
    s_sub_u32 s68, s68, 1
    s_waitcnt lgkmcnt(0)
    v_readfirstlane_b32 s69, v13
    s_cmp_eq_u32 s68, 0
    s_cbranch_scc1 L_paird
    s_cmp_eq_u32 s69, 0
    s_cbranch_scc1 L_pair
L_paird:
    ds_read_b128 v[144:147], v9 offset:0
    ds_read_b128 v[148:151], v9 offset:1024
    ds_read_b128 v[152:155], v9 offset:2048
    ds_read_b128 v[156:159], v9 offset:3072
    s_lshl_b32 s68, s43, 12
    s_lshl_b32 s69, s90, 11
    s_add_u32 s68, s68, s69
    s_add_u32 s68, s68, 10485760
    v_lshlrev_b32 v8, 5, v3
    v_lshl_add_u32 v8, v1, 3, v8
    s_lshl_b32 s42, s90, 9
    s_add_u32 s42, s42, s43
    s_lshl_b32 s42, s42, 7
    s_add_u32 s42, s42, 13795328
    s_waitcnt lgkmcnt(3)
    v_add_f32 v128, v128, v144
    v_add_f32 v129, v129, v145
    v_add_f32 v130, v130, v146
    v_add_f32 v131, v131, v147
    v_cvt_pk_bf16_f32 v96, v128, v129
    v_cvt_pk_bf16_f32 v97, v130, v131
    buffer_store_dwordx2 v[96:97], v8, s[44:47], s68 offen offset:0 sc1
    s_waitcnt lgkmcnt(2)
    v_add_f32 v132, v132, v148
    v_add_f32 v133, v133, v149
    v_add_f32 v134, v134, v150
    v_add_f32 v135, v135, v151
    v_cvt_pk_bf16_f32 v98, v132, v133
    v_cvt_pk_bf16_f32 v99, v134, v135
    buffer_store_dwordx2 v[98:99], v8, s[44:47], s68 offen offset:512 sc1
    s_waitcnt lgkmcnt(1)
    v_add_f32 v136, v136, v152
    v_add_f32 v137, v137, v153
    v_add_f32 v138, v138, v154
    v_add_f32 v139, v139, v155
    v_cvt_pk_bf16_f32 v100, v136, v137
    v_cvt_pk_bf16_f32 v101, v138, v139
    buffer_store_dwordx2 v[100:101], v8, s[44:47], s68 offen offset:1024 sc1
    s_waitcnt lgkmcnt(0)
    v_add_f32 v140, v140, v156
    v_add_f32 v141, v141, v157
    v_add_f32 v142, v142, v158
    v_add_f32 v143, v143, v159
    v_cvt_pk_bf16_f32 v102, v140, v141
    v_cvt_pk_bf16_f32 v103, v142, v143
    buffer_store_dwordx2 v[102:103], v8, s[44:47], s68 offen offset:1536 sc1
    s_waitcnt vmcnt(0)
    v_mov_b32 v28, s6
    v_mov_b32 v29, s7
    s_mov_b64 exec, 1
    buffer_store_dwordx2 v[28:29], off, s[44:47], s42 sc1
    s_mov_b64 exec, -1
    s_lshr_b32 s42, s76, 4
    s_lshl_b32 s42, s42, 9
    s_lshl_b32 s68, s77, 6
    s_lshl_b32 s69, s3, 4
    s_add_u32 s85, s68, s69
    s_sub_u32 s85, s85, 64
    s_add_u32 s42, s42, s85
    s_lshl_b32 s42, s42, 7
    s_add_u32 s42, s42, 13795328
    v_lshlrev_b32 v8, 7, v3
    v_lshrrev_b32 v10, 3, v2
    v_and_b32 v11, 7, v2
    v_lshlrev_b32 v10, 12, v10
    v_lshl_add_u32 v10, v11, 4, v10
    s_lshl_b32 s85, s85, 12
    s_lshl_b32 s69, s76, 7
    s_add_u32 s85, s85, s69
    s_add_u32 s85, s85, 10485760
    s_add_u32 s86, s85, 32768
    buffer_load_dwordx2 v[28:29], v8, s[44:47], s42 offen sc1
    s_waitcnt vmcnt(0)
    s_mov_b32 s68, 200000
pl_7:
    v_cmp_ne_u64 vcc, s[6:7], v[28:29]
    s_cbranch_vccz pld_8
    s_sleep 4
    buffer_load_dwordx2 v[28:29], v8, s[44:47], s42 offen sc1
    s_sub_u32 s68, s68, 1
    s_cmp_lg_u32 s68, 0
    s_waitcnt vmcnt(0)
    s_cbranch_scc1 pl_7
pld_8:
    buffer_load_dwordx4 v[32:35], v10, s[44:47], s85 offen sc1
    buffer_load_dwordx4 v[36:39], v10, s[44:47], s86 offen sc1
    s_waitcnt vmcnt(1)
    ds_write_b128 v9, v[32:35]
    s_waitcnt vmcnt(0)
    ds_write_b128 v9, v[36:39] offset:1024
L_fin:
    s_and_b32 s82, s3, 3
    s_lshr_b32 s83, s3, 2
    s_lshl_b32 s68, s83, 3
    v_lshl_add_u32 v8, v1, 1, s68
    v_xor_b32 v8, v8, v3
    v_lshlrev_b32 v8, 4, v8
    v_lshl_add_u32 v8, v3, 8, v8
    s_lshl_b32 s68, s82, 14
    v_add_u32 v8, s68, v8
    v_xor_b32 v9, 16, v8
    s_lshl_b32 s68, s82, 7
    s_add_u32 s68, s68, 162304
    v_lshl_add_u32 v10, v3, 3, s68
    v_lshrrev_b32 v11, 2, v3
    v_and_b32 v12, 1, v1
    v_lshl_add_u32 v11, v12, 3, v11
    v_lshlrev_b32 v11, 7, v11
    v_lshrrev_b32 v12, 1, v1
    v_lshl_add_u32 v11, v12, 12, v11
    v_and_b32 v12, 3, v3
    v_lshl_add_u32 v11, v12, 3, v11
    s_lshl_b32 s68, s83, 13
    s_lshl_b32 s69, s82, 5
    s_add_u32 s68, s68, s69
    s_add_u32 s68, s68, 140800
    v_add_u32 v11, s68, v11
    s_waitcnt vmcnt(0) lgkmcnt(0)
    s_barrier
    ds_read_b64 v[12:13], v10
    ds_read_b64_tr_b16 v[16:17], v11
    ds_read_b64_tr_b16 v[18:19], v11 offset:512
    ds_read_b128 v[32:35], v8 offset:0
    ds_read_b128 v[36:39], v9 offset:0
    ds_read_b128 v[40:43], v8 offset:4096
    ds_read_b128 v[44:47], v9 offset:4096
    ds_read_b128 v[48:51], v8 offset:8192
    ds_read_b128 v[52:55], v9 offset:8192
    ds_read_b128 v[56:59], v8 offset:12288
    ds_read_b128 v[60:63], v9 offset:12288
    s_mov_b32 s48, s36
    s_and_b32 s49, s37, 0xffff
    s_mov_b32 s50, 2097152
    s_mov_b32 s51, 0x20000
    v_lshlrev_b32 v64, 16, v4
    v_and_b32 v65, 0xffff0000, v4
    v_lshlrev_b32 v66, 16, v5
    v_and_b32 v67, 0xffff0000, v5
    v_lshlrev_b32 v68, 16, v6
    v_and_b32 v69, 0xffff0000, v6
    v_lshlrev_b32 v70, 16, v7
    v_and_b32 v71, 0xffff0000, v7
    s_waitcnt lgkmcnt(8)
    v_lshlrev_b32 v72, 16, v16
    v_and_b32 v73, 0xffff0000, v16
    v_lshlrev_b32 v74, 16, v17
    v_and_b32 v75, 0xffff0000, v17
    v_lshlrev_b32 v76, 16, v18
    v_and_b32 v77, 0xffff0000, v18
    v_lshlrev_b32 v78, 16, v19
    v_and_b32 v79, 0xffff0000, v19
    v_pk_add_f32 v[80:81], v[64:65], v[12:13] op_sel_hi:[1,0] neg_lo:[0,1] neg_hi:[0,1]
    v_pk_add_f32 v[82:83], v[66:67], v[12:13] op_sel_hi:[1,0] neg_lo:[0,1] neg_hi:[0,1]
    v_pk_add_f32 v[84:85], v[68:69], v[12:13] op_sel_hi:[1,0] neg_lo:[0,1] neg_hi:[0,1]
    v_pk_add_f32 v[86:87], v[70:71], v[12:13] op_sel_hi:[1,0] neg_lo:[0,1] neg_hi:[0,1]
    v_pk_mul_f32 v[80:81], v[80:81], v[12:13] op_sel:[0,1] op_sel_hi:[1,1]
    v_pk_mul_f32 v[82:83], v[82:83], v[12:13] op_sel:[0,1] op_sel_hi:[1,1]
    v_pk_mul_f32 v[84:85], v[84:85], v[12:13] op_sel:[0,1] op_sel_hi:[1,1]
    v_pk_mul_f32 v[86:87], v[86:87], v[12:13] op_sel:[0,1] op_sel_hi:[1,1]
    v_pk_fma_f32 v[64:65], v[80:81], v[72:73], v[64:65]
    v_pk_fma_f32 v[66:67], v[82:83], v[74:75], v[66:67]
    v_pk_fma_f32 v[68:69], v[84:85], v[76:77], v[68:69]
    v_pk_fma_f32 v[70:71], v[86:87], v[78:79], v[70:71]
    s_waitcnt lgkmcnt(0)
    v_pk_add_f32 v[32:33], v[32:33], v[40:41]
    v_pk_add_f32 v[48:49], v[48:49], v[56:57]
    v_pk_add_f32 v[34:35], v[34:35], v[42:43]
    v_pk_add_f32 v[50:51], v[50:51], v[58:59]
    v_pk_add_f32 v[36:37], v[36:37], v[44:45]
    v_pk_add_f32 v[52:53], v[52:53], v[60:61]
    v_pk_add_f32 v[38:39], v[38:39], v[46:47]
    v_pk_add_f32 v[54:55], v[54:55], v[62:63]
    v_pk_add_f32 v[64:65], v[64:65], v[32:33]
    v_pk_add_f32 v[66:67], v[66:67], v[34:35]
    v_pk_add_f32 v[68:69], v[68:69], v[36:37]
    v_pk_add_f32 v[70:71], v[70:71], v[38:39]
    v_pk_add_f32 v[64:65], v[64:65], v[48:49]
    v_pk_add_f32 v[66:67], v[66:67], v[50:51]
    v_pk_add_f32 v[68:69], v[68:69], v[52:53]
    v_pk_add_f32 v[70:71], v[70:71], v[54:55]
    v_cvt_pk_bf16_f32 v4, v64, v65
    v_cvt_pk_bf16_f32 v5, v66, v67
    v_cvt_pk_bf16_f32 v6, v68, v69
    v_cvt_pk_bf16_f32 v7, v70, v71
    buffer_store_dwordx4 v[4:7], v26, s[48:51], 0 offen
    s_endpgm
L_prep:
    v_lshrrev_b32 v4, 3, v2
    v_and_b32 v5, 7, v2
    s_mov_b32 s52, s16
    s_and_b32 s53, s17, 0xffff
    s_mov_b32 s54, 2097152
    s_mov_b32 s55, 0x20000
    s_lshl_b32 s8, s4, 2
    s_add_u32 s8, s8, s5
    s_lshl_b32 s14, s8, 16
    s_lshl_b32 s69, s3, 13
    s_add_u32 s14, s14, s69
    v_lshlrev_b32 v15, 10, v4
    v_lshl_add_u32 v15, v5, 4, v15
    s_nop 0
    s_mov_b32 s56, s18
    s_and_b32 s57, s19, 0xffff
    s_mov_b32 s58, 2097152
    s_mov_b32 s59, 0x20000
    s_mov_b32 s60, s20
    s_and_b32 s61, s21, 0xffff
    s_mov_b32 s62, 2097152
    s_mov_b32 s63, 0x20000
    s_mov_b32 s48, s22
    s_and_b32 s49, s23, 0xffff
    s_mov_b32 s50, 4096
    s_mov_b32 s51, 0x20000
    s_lshl_b32 s68, s8, 16
    v_lshl_add_u32 v8, v2, 4, s14
    v_add_u32 v9, 4096, v8
    v_subrev_u32 v10, 3072, v8
    v_subrev_u32 v11, 2048, v8
    v_subrev_u32 v12, 1024, v8
    v_lshlrev_b32 v13, 6, v2
    s_mov_b32 s68, 0
    buffer_load_dwordx4 v[204:207], v13, s[48:51], s68 offen offset:0
    buffer_load_dwordx4 v[208:211], v13, s[48:51], s68 offen offset:16
    buffer_load_dwordx4 v[212:215], v13, s[48:51], s68 offen offset:32
    buffer_load_dwordx4 v[216:219], v13, s[48:51], s68 offen offset:48
    buffer_load_dwordx4 v[128:131], v10, s[56:59], 0 offen
    buffer_load_dwordx4 v[132:135], v11, s[56:59], 0 offen
    buffer_load_dwordx4 v[136:139], v12, s[56:59], 0 offen
    buffer_load_dwordx4 v[140:143], v8, s[56:59], 0 offen offset:0 nt
    buffer_load_dwordx4 v[172:175], v8, s[60:63], 0 offen offset:0 nt
    buffer_load_dwordx4 v[144:147], v8, s[56:59], 0 offen offset:1024 nt
    buffer_load_dwordx4 v[176:179], v8, s[60:63], 0 offen offset:1024 nt
    buffer_load_dwordx4 v[148:151], v8, s[56:59], 0 offen offset:2048 nt
    buffer_load_dwordx4 v[180:183], v8, s[60:63], 0 offen offset:2048 nt
    buffer_load_dwordx4 v[152:155], v8, s[56:59], 0 offen offset:3072 nt
    buffer_load_dwordx4 v[184:187], v8, s[60:63], 0 offen offset:3072 nt
    buffer_load_dwordx4 v[156:159], v9, s[56:59], 0 offen offset:0 nt
    buffer_load_dwordx4 v[188:191], v9, s[60:63], 0 offen offset:0 nt
    buffer_load_dwordx4 v[160:163], v9, s[56:59], 0 offen offset:1024 nt
    buffer_load_dwordx4 v[192:195], v9, s[60:63], 0 offen offset:1024 nt
    buffer_load_dwordx4 v[164:167], v9, s[56:59], 0 offen offset:2048 nt
    buffer_load_dwordx4 v[196:199], v9, s[60:63], 0 offen offset:2048 nt
    buffer_load_dwordx4 v[168:171], v9, s[56:59], 0 offen offset:3072 nt
    buffer_load_dwordx4 v[200:203], v9, s[60:63], 0 offen offset:3072 nt
    s_waitcnt vmcnt(19)
    v_lshlrev_b32 v32, 16, v204
    v_and_b32 v40, 0xffff0000, v204
    v_lshlrev_b32 v48, 16, v205
    v_and_b32 v56, 0xffff0000, v205
    v_lshlrev_b32 v33, 16, v206
    v_and_b32 v41, 0xffff0000, v206
    v_lshlrev_b32 v49, 16, v207
    v_and_b32 v57, 0xffff0000, v207
    v_lshlrev_b32 v34, 16, v208
    v_and_b32 v42, 0xffff0000, v208
    v_lshlrev_b32 v50, 16, v209
    v_and_b32 v58, 0xffff0000, v209
    v_lshlrev_b32 v35, 16, v210
    v_and_b32 v43, 0xffff0000, v210
    v_lshlrev_b32 v51, 16, v211
    v_and_b32 v59, 0xffff0000, v211
    v_lshlrev_b32 v36, 16, v212
    v_and_b32 v44, 0xffff0000, v212
    v_lshlrev_b32 v52, 16, v213
    v_and_b32 v60, 0xffff0000, v213
    v_lshlrev_b32 v37, 16, v214
    v_and_b32 v45, 0xffff0000, v214
    v_lshlrev_b32 v53, 16, v215
    v_and_b32 v61, 0xffff0000, v215
    v_lshlrev_b32 v38, 16, v216
    v_and_b32 v46, 0xffff0000, v216
    v_lshlrev_b32 v54, 16, v217
    v_and_b32 v62, 0xffff0000, v217
    v_lshlrev_b32 v39, 16, v218
    v_and_b32 v47, 0xffff0000, v218
    v_lshlrev_b32 v55, 16, v219
    v_and_b32 v63, 0xffff0000, v219
    s_waitcnt vmcnt(16)
    v_lshlrev_b32 v220, 16, v128
    v_and_b32 v221, 0xffff0000, v128
    v_lshlrev_b32 v222, 16, v129
    v_and_b32 v223, 0xffff0000, v129
    v_lshlrev_b32 v224, 16, v130
    v_and_b32 v225, 0xffff0000, v130
    v_lshlrev_b32 v226, 16, v131
    v_and_b32 v227, 0xffff0000, v131
    v_lshlrev_b32 v228, 16, v132
    v_and_b32 v229, 0xffff0000, v132
    v_lshlrev_b32 v230, 16, v133
    v_and_b32 v231, 0xffff0000, v133
    v_lshlrev_b32 v232, 16, v134
    v_and_b32 v233, 0xffff0000, v134
    v_lshlrev_b32 v234, 16, v135
    v_and_b32 v235, 0xffff0000, v135
    v_lshlrev_b32 v236, 16, v136
    v_and_b32 v237, 0xffff0000, v136
    v_lshlrev_b32 v238, 16, v137
    v_and_b32 v239, 0xffff0000, v137
    v_lshlrev_b32 v240, 16, v138
    v_and_b32 v241, 0xffff0000, v138
    v_lshlrev_b32 v242, 16, v139
    v_and_b32 v243, 0xffff0000, v139
    s_waitcnt vmcnt(14)
    v_lshlrev_b32 v244, 16, v140
    v_and_b32 v245, 0xffff0000, v140
    v_lshlrev_b32 v246, 16, v141
    v_and_b32 v247, 0xffff0000, v141
    v_lshlrev_b32 v248, 16, v142
    v_and_b32 v249, 0xffff0000, v142
    v_lshlrev_b32 v250, 16, v143
    v_and_b32 v251, 0xffff0000, v143
    v_lshlrev_b32 v16, 16, v172
    v_and_b32 v17, 0xffff0000, v172
    v_lshlrev_b32 v18, 16, v173
    v_and_b32 v19, 0xffff0000, v173
    v_lshlrev_b32 v20, 16, v174
    v_and_b32 v21, 0xffff0000, v174
    v_lshlrev_b32 v22, 16, v175
    v_and_b32 v23, 0xffff0000, v175
    v_pk_mul_f32 v[64:65], v[220:221], v[56:57]
    v_pk_mul_f32 v[66:67], v[222:223], v[58:59]
    v_pk_mul_f32 v[68:69], v[224:225], v[60:61]
    v_pk_mul_f32 v[70:71], v[226:227], v[62:63]
    v_pk_fma_f32 v[64:65], v[228:229], v[48:49], v[64:65]
    v_pk_fma_f32 v[66:67], v[230:231], v[50:51], v[66:67]
    v_pk_fma_f32 v[68:69], v[232:233], v[52:53], v[68:69]
    v_pk_fma_f32 v[70:71], v[234:235], v[54:55], v[70:71]
    v_pk_fma_f32 v[64:65], v[236:237], v[40:41], v[64:65]
    v_pk_fma_f32 v[66:67], v[238:239], v[42:43], v[66:67]
    v_pk_fma_f32 v[68:69], v[240:241], v[44:45], v[68:69]
    v_pk_fma_f32 v[70:71], v[242:243], v[46:47], v[70:71]
    v_pk_fma_f32 v[64:65], v[244:245], v[32:33], v[64:65]
    v_pk_fma_f32 v[66:67], v[246:247], v[34:35], v[66:67]
    v_pk_fma_f32 v[68:69], v[248:249], v[36:37], v[68:69]
    v_pk_fma_f32 v[70:71], v[250:251], v[38:39], v[70:71]
    v_pk_mul_f32 v[64:65], v[64:65], v[16:17]
    v_pk_mul_f32 v[66:67], v[66:67], v[18:19]
    v_pk_mul_f32 v[68:69], v[68:69], v[20:21]
    v_pk_mul_f32 v[70:71], v[70:71], v[22:23]
    s_waitcnt vmcnt(12)
    v_lshlrev_b32 v220, 16, v144
    v_and_b32 v221, 0xffff0000, v144
    v_lshlrev_b32 v222, 16, v145
    v_and_b32 v223, 0xffff0000, v145
    v_lshlrev_b32 v224, 16, v146
    v_and_b32 v225, 0xffff0000, v146
    v_lshlrev_b32 v226, 16, v147
    v_and_b32 v227, 0xffff0000, v147
    v_lshlrev_b32 v16, 16, v176
    v_and_b32 v17, 0xffff0000, v176
    v_lshlrev_b32 v18, 16, v177
    v_and_b32 v19, 0xffff0000, v177
    v_lshlrev_b32 v20, 16, v178
    v_and_b32 v21, 0xffff0000, v178
    v_lshlrev_b32 v22, 16, v179
    v_and_b32 v23, 0xffff0000, v179
    v_pk_mul_f32 v[72:73], v[228:229], v[56:57]
    v_pk_mul_f32 v[74:75], v[230:231], v[58:59]
    v_pk_mul_f32 v[76:77], v[232:233], v[60:61]
    v_pk_mul_f32 v[78:79], v[234:235], v[62:63]
    v_pk_fma_f32 v[72:73], v[236:237], v[48:49], v[72:73]
    v_pk_fma_f32 v[74:75], v[238:239], v[50:51], v[74:75]
    v_pk_fma_f32 v[76:77], v[240:241], v[52:53], v[76:77]
    v_pk_fma_f32 v[78:79], v[242:243], v[54:55], v[78:79]
    v_pk_fma_f32 v[72:73], v[244:245], v[40:41], v[72:73]
    v_pk_fma_f32 v[74:75], v[246:247], v[42:43], v[74:75]
    v_pk_fma_f32 v[76:77], v[248:249], v[44:45], v[76:77]
    v_pk_fma_f32 v[78:79], v[250:251], v[46:47], v[78:79]
    v_pk_fma_f32 v[72:73], v[220:221], v[32:33], v[72:73]
    v_pk_fma_f32 v[74:75], v[222:223], v[34:35], v[74:75]
    v_pk_fma_f32 v[76:77], v[224:225], v[36:37], v[76:77]
    v_pk_fma_f32 v[78:79], v[226:227], v[38:39], v[78:79]
    v_pk_mul_f32 v[72:73], v[72:73], v[16:17]
    v_pk_mul_f32 v[74:75], v[74:75], v[18:19]
    v_pk_mul_f32 v[76:77], v[76:77], v[20:21]
    v_pk_mul_f32 v[78:79], v[78:79], v[22:23]
    s_waitcnt vmcnt(10)
    v_lshlrev_b32 v228, 16, v148
    v_and_b32 v229, 0xffff0000, v148
    v_lshlrev_b32 v230, 16, v149
    v_and_b32 v231, 0xffff0000, v149
    v_lshlrev_b32 v232, 16, v150
    v_and_b32 v233, 0xffff0000, v150
    v_lshlrev_b32 v234, 16, v151
    v_and_b32 v235, 0xffff0000, v151
    v_lshlrev_b32 v16, 16, v180
    v_and_b32 v17, 0xffff0000, v180
    v_lshlrev_b32 v18, 16, v181
    v_and_b32 v19, 0xffff0000, v181
    v_lshlrev_b32 v20, 16, v182
    v_and_b32 v21, 0xffff0000, v182
    v_lshlrev_b32 v22, 16, v183
    v_and_b32 v23, 0xffff0000, v183
    v_pk_mul_f32 v[80:81], v[236:237], v[56:57]
    v_pk_mul_f32 v[82:83], v[238:239], v[58:59]
    v_pk_mul_f32 v[84:85], v[240:241], v[60:61]
    v_pk_mul_f32 v[86:87], v[242:243], v[62:63]
    v_pk_fma_f32 v[80:81], v[244:245], v[48:49], v[80:81]
    v_pk_fma_f32 v[82:83], v[246:247], v[50:51], v[82:83]
    v_pk_fma_f32 v[84:85], v[248:249], v[52:53], v[84:85]
    v_pk_fma_f32 v[86:87], v[250:251], v[54:55], v[86:87]
    v_pk_fma_f32 v[80:81], v[220:221], v[40:41], v[80:81]
    v_pk_fma_f32 v[82:83], v[222:223], v[42:43], v[82:83]
    v_pk_fma_f32 v[84:85], v[224:225], v[44:45], v[84:85]
    v_pk_fma_f32 v[86:87], v[226:227], v[46:47], v[86:87]
    v_pk_fma_f32 v[80:81], v[228:229], v[32:33], v[80:81]
    v_pk_fma_f32 v[82:83], v[230:231], v[34:35], v[82:83]
    v_pk_fma_f32 v[84:85], v[232:233], v[36:37], v[84:85]
    v_pk_fma_f32 v[86:87], v[234:235], v[38:39], v[86:87]
    v_pk_mul_f32 v[80:81], v[80:81], v[16:17]
    v_pk_mul_f32 v[82:83], v[82:83], v[18:19]
    v_pk_mul_f32 v[84:85], v[84:85], v[20:21]
    v_pk_mul_f32 v[86:87], v[86:87], v[22:23]
    s_waitcnt vmcnt(8)
    v_lshlrev_b32 v236, 16, v152
    v_and_b32 v237, 0xffff0000, v152
    v_lshlrev_b32 v238, 16, v153
    v_and_b32 v239, 0xffff0000, v153
    v_lshlrev_b32 v240, 16, v154
    v_and_b32 v241, 0xffff0000, v154
    v_lshlrev_b32 v242, 16, v155
    v_and_b32 v243, 0xffff0000, v155
    v_lshlrev_b32 v16, 16, v184
    v_and_b32 v17, 0xffff0000, v184
    v_lshlrev_b32 v18, 16, v185
    v_and_b32 v19, 0xffff0000, v185
    v_lshlrev_b32 v20, 16, v186
    v_and_b32 v21, 0xffff0000, v186
    v_lshlrev_b32 v22, 16, v187
    v_and_b32 v23, 0xffff0000, v187
    v_pk_mul_f32 v[88:89], v[244:245], v[56:57]
    v_pk_mul_f32 v[90:91], v[246:247], v[58:59]
    v_pk_mul_f32 v[92:93], v[248:249], v[60:61]
    v_pk_mul_f32 v[94:95], v[250:251], v[62:63]
    v_pk_fma_f32 v[88:89], v[220:221], v[48:49], v[88:89]
    v_pk_fma_f32 v[90:91], v[222:223], v[50:51], v[90:91]
    v_pk_fma_f32 v[92:93], v[224:225], v[52:53], v[92:93]
    v_pk_fma_f32 v[94:95], v[226:227], v[54:55], v[94:95]
    v_pk_fma_f32 v[88:89], v[228:229], v[40:41], v[88:89]
    v_pk_fma_f32 v[90:91], v[230:231], v[42:43], v[90:91]
    v_pk_fma_f32 v[92:93], v[232:233], v[44:45], v[92:93]
    v_pk_fma_f32 v[94:95], v[234:235], v[46:47], v[94:95]
    v_pk_fma_f32 v[88:89], v[236:237], v[32:33], v[88:89]
    v_pk_fma_f32 v[90:91], v[238:239], v[34:35], v[90:91]
    v_pk_fma_f32 v[92:93], v[240:241], v[36:37], v[92:93]
    v_pk_fma_f32 v[94:95], v[242:243], v[38:39], v[94:95]
    v_pk_mul_f32 v[88:89], v[88:89], v[16:17]
    v_pk_mul_f32 v[90:91], v[90:91], v[18:19]
    v_pk_mul_f32 v[92:93], v[92:93], v[20:21]
    v_pk_mul_f32 v[94:95], v[94:95], v[22:23]
    s_waitcnt vmcnt(6)
    v_lshlrev_b32 v244, 16, v156
    v_and_b32 v245, 0xffff0000, v156
    v_lshlrev_b32 v246, 16, v157
    v_and_b32 v247, 0xffff0000, v157
    v_lshlrev_b32 v248, 16, v158
    v_and_b32 v249, 0xffff0000, v158
    v_lshlrev_b32 v250, 16, v159
    v_and_b32 v251, 0xffff0000, v159
    v_lshlrev_b32 v16, 16, v188
    v_and_b32 v17, 0xffff0000, v188
    v_lshlrev_b32 v18, 16, v189
    v_and_b32 v19, 0xffff0000, v189
    v_lshlrev_b32 v20, 16, v190
    v_and_b32 v21, 0xffff0000, v190
    v_lshlrev_b32 v22, 16, v191
    v_and_b32 v23, 0xffff0000, v191
    v_pk_mul_f32 v[96:97], v[220:221], v[56:57]
    v_pk_mul_f32 v[98:99], v[222:223], v[58:59]
    v_pk_mul_f32 v[100:101], v[224:225], v[60:61]
    v_pk_mul_f32 v[102:103], v[226:227], v[62:63]
    v_pk_fma_f32 v[96:97], v[228:229], v[48:49], v[96:97]
    v_pk_fma_f32 v[98:99], v[230:231], v[50:51], v[98:99]
    v_pk_fma_f32 v[100:101], v[232:233], v[52:53], v[100:101]
    v_pk_fma_f32 v[102:103], v[234:235], v[54:55], v[102:103]
    v_pk_fma_f32 v[96:97], v[236:237], v[40:41], v[96:97]
    v_pk_fma_f32 v[98:99], v[238:239], v[42:43], v[98:99]
    v_pk_fma_f32 v[100:101], v[240:241], v[44:45], v[100:101]
    v_pk_fma_f32 v[102:103], v[242:243], v[46:47], v[102:103]
    v_pk_fma_f32 v[96:97], v[244:245], v[32:33], v[96:97]
    v_pk_fma_f32 v[98:99], v[246:247], v[34:35], v[98:99]
    v_pk_fma_f32 v[100:101], v[248:249], v[36:37], v[100:101]
    v_pk_fma_f32 v[102:103], v[250:251], v[38:39], v[102:103]
    v_pk_mul_f32 v[96:97], v[96:97], v[16:17]
    v_pk_mul_f32 v[98:99], v[98:99], v[18:19]
    v_pk_mul_f32 v[100:101], v[100:101], v[20:21]
    v_pk_mul_f32 v[102:103], v[102:103], v[22:23]
    s_waitcnt vmcnt(4)
    v_lshlrev_b32 v220, 16, v160
    v_and_b32 v221, 0xffff0000, v160
    v_lshlrev_b32 v222, 16, v161
    v_and_b32 v223, 0xffff0000, v161
    v_lshlrev_b32 v224, 16, v162
    v_and_b32 v225, 0xffff0000, v162
    v_lshlrev_b32 v226, 16, v163
    v_and_b32 v227, 0xffff0000, v163
    v_lshlrev_b32 v16, 16, v192
    v_and_b32 v17, 0xffff0000, v192
    v_lshlrev_b32 v18, 16, v193
    v_and_b32 v19, 0xffff0000, v193
    v_lshlrev_b32 v20, 16, v194
    v_and_b32 v21, 0xffff0000, v194
    v_lshlrev_b32 v22, 16, v195
    v_and_b32 v23, 0xffff0000, v195
    v_pk_mul_f32 v[104:105], v[228:229], v[56:57]
    v_pk_mul_f32 v[106:107], v[230:231], v[58:59]
    v_pk_mul_f32 v[108:109], v[232:233], v[60:61]
    v_pk_mul_f32 v[110:111], v[234:235], v[62:63]
    v_pk_fma_f32 v[104:105], v[236:237], v[48:49], v[104:105]
    v_pk_fma_f32 v[106:107], v[238:239], v[50:51], v[106:107]
    v_pk_fma_f32 v[108:109], v[240:241], v[52:53], v[108:109]
    v_pk_fma_f32 v[110:111], v[242:243], v[54:55], v[110:111]
    v_pk_fma_f32 v[104:105], v[244:245], v[40:41], v[104:105]
    v_pk_fma_f32 v[106:107], v[246:247], v[42:43], v[106:107]
    v_pk_fma_f32 v[108:109], v[248:249], v[44:45], v[108:109]
    v_pk_fma_f32 v[110:111], v[250:251], v[46:47], v[110:111]
    v_pk_fma_f32 v[104:105], v[220:221], v[32:33], v[104:105]
    v_pk_fma_f32 v[106:107], v[222:223], v[34:35], v[106:107]
    v_pk_fma_f32 v[108:109], v[224:225], v[36:37], v[108:109]
    v_pk_fma_f32 v[110:111], v[226:227], v[38:39], v[110:111]
    v_pk_mul_f32 v[104:105], v[104:105], v[16:17]
    v_pk_mul_f32 v[106:107], v[106:107], v[18:19]
    v_pk_mul_f32 v[108:109], v[108:109], v[20:21]
    v_pk_mul_f32 v[110:111], v[110:111], v[22:23]
    s_waitcnt vmcnt(2)
    v_lshlrev_b32 v228, 16, v164
    v_and_b32 v229, 0xffff0000, v164
    v_lshlrev_b32 v230, 16, v165
    v_and_b32 v231, 0xffff0000, v165
    v_lshlrev_b32 v232, 16, v166
    v_and_b32 v233, 0xffff0000, v166
    v_lshlrev_b32 v234, 16, v167
    v_and_b32 v235, 0xffff0000, v167
    v_lshlrev_b32 v16, 16, v196
    v_and_b32 v17, 0xffff0000, v196
    v_lshlrev_b32 v18, 16, v197
    v_and_b32 v19, 0xffff0000, v197
    v_lshlrev_b32 v20, 16, v198
    v_and_b32 v21, 0xffff0000, v198
    v_lshlrev_b32 v22, 16, v199
    v_and_b32 v23, 0xffff0000, v199
    v_pk_mul_f32 v[112:113], v[236:237], v[56:57]
    v_pk_mul_f32 v[114:115], v[238:239], v[58:59]
    v_pk_mul_f32 v[116:117], v[240:241], v[60:61]
    v_pk_mul_f32 v[118:119], v[242:243], v[62:63]
    v_pk_fma_f32 v[112:113], v[244:245], v[48:49], v[112:113]
    v_pk_fma_f32 v[114:115], v[246:247], v[50:51], v[114:115]
    v_pk_fma_f32 v[116:117], v[248:249], v[52:53], v[116:117]
    v_pk_fma_f32 v[118:119], v[250:251], v[54:55], v[118:119]
    v_pk_fma_f32 v[112:113], v[220:221], v[40:41], v[112:113]
    v_pk_fma_f32 v[114:115], v[222:223], v[42:43], v[114:115]
    v_pk_fma_f32 v[116:117], v[224:225], v[44:45], v[116:117]
    v_pk_fma_f32 v[118:119], v[226:227], v[46:47], v[118:119]
    v_pk_fma_f32 v[112:113], v[228:229], v[32:33], v[112:113]
    v_pk_fma_f32 v[114:115], v[230:231], v[34:35], v[114:115]
    v_pk_fma_f32 v[116:117], v[232:233], v[36:37], v[116:117]
    v_pk_fma_f32 v[118:119], v[234:235], v[38:39], v[118:119]
    v_pk_mul_f32 v[112:113], v[112:113], v[16:17]
    v_pk_mul_f32 v[114:115], v[114:115], v[18:19]
    v_pk_mul_f32 v[116:117], v[116:117], v[20:21]
    v_pk_mul_f32 v[118:119], v[118:119], v[22:23]
    s_waitcnt vmcnt(0)
    v_lshlrev_b32 v236, 16, v168
    v_and_b32 v237, 0xffff0000, v168
    v_lshlrev_b32 v238, 16, v169
    v_and_b32 v239, 0xffff0000, v169
    v_lshlrev_b32 v240, 16, v170
    v_and_b32 v241, 0xffff0000, v170
    v_lshlrev_b32 v242, 16, v171
    v_and_b32 v243, 0xffff0000, v171
    v_lshlrev_b32 v16, 16, v200
    v_and_b32 v17, 0xffff0000, v200
    v_lshlrev_b32 v18, 16, v201
    v_and_b32 v19, 0xffff0000, v201
    v_lshlrev_b32 v20, 16, v202
    v_and_b32 v21, 0xffff0000, v202
    v_lshlrev_b32 v22, 16, v203
    v_and_b32 v23, 0xffff0000, v203
    v_pk_mul_f32 v[120:121], v[244:245], v[56:57]
    v_pk_mul_f32 v[122:123], v[246:247], v[58:59]
    v_pk_mul_f32 v[124:125], v[248:249], v[60:61]
    v_pk_mul_f32 v[126:127], v[250:251], v[62:63]
    v_pk_fma_f32 v[120:121], v[220:221], v[48:49], v[120:121]
    v_pk_fma_f32 v[122:123], v[222:223], v[50:51], v[122:123]
    v_pk_fma_f32 v[124:125], v[224:225], v[52:53], v[124:125]
    v_pk_fma_f32 v[126:127], v[226:227], v[54:55], v[126:127]
    v_pk_fma_f32 v[120:121], v[228:229], v[40:41], v[120:121]
    v_pk_fma_f32 v[122:123], v[230:231], v[42:43], v[122:123]
    v_pk_fma_f32 v[124:125], v[232:233], v[44:45], v[124:125]
    v_pk_fma_f32 v[126:127], v[234:235], v[46:47], v[126:127]
    v_pk_fma_f32 v[120:121], v[236:237], v[32:33], v[120:121]
    v_pk_fma_f32 v[122:123], v[238:239], v[34:35], v[122:123]
    v_pk_fma_f32 v[124:125], v[240:241], v[36:37], v[124:125]
    v_pk_fma_f32 v[126:127], v[242:243], v[38:39], v[126:127]
    v_pk_mul_f32 v[120:121], v[120:121], v[16:17]
    v_pk_mul_f32 v[122:123], v[122:123], v[18:19]
    v_pk_mul_f32 v[124:125], v[124:125], v[20:21]
    v_pk_mul_f32 v[126:127], v[126:127], v[22:23]
    s_and_b32 s9, s4, 3
    s_lshl_b32 s9, s9, 3
    s_and_b32 s68, s4, 4
    s_add_u32 s9, s9, s68
    s_add_u32 s9, s9, s5
    s_lshl_b32 s14, s9, 16
    s_lshl_b32 s69, s3, 13
    s_add_u32 s14, s14, s69
    buffer_load_dwordx4 v[192:195], v15, s[52:55], s14 offen offset:0
    buffer_load_dwordx4 v[196:199], v15, s[52:55], s14 offen offset:128
    buffer_load_dwordx4 v[200:203], v15, s[52:55], s14 offen offset:256
    buffer_load_dwordx4 v[204:207], v15, s[52:55], s14 offen offset:384
    buffer_load_dwordx4 v[208:211], v15, s[52:55], s14 offen offset:512
    buffer_load_dwordx4 v[212:215], v15, s[52:55], s14 offen offset:640
    buffer_load_dwordx4 v[216:219], v15, s[52:55], s14 offen offset:768
    buffer_load_dwordx4 v[220:223], v15, s[52:55], s14 offen offset:896
    buffer_load_dwordx2 v[30:31], off, s[64:67], 0
    s_lshl_b32 s68, s3, 13
    s_add_u32 s68, s68, 32768
    v_xor_b32 v6, s3, v5
    v_lshlrev_b32 v6, 4, v6
    v_lshl_add_u32 v6, v2, 10, v6
    v_add_u32 v6, 32768, v6
    v_lshl_add_u32 v7, v2, 4, s68
    v_cvt_pk_bf16_f32 v128, v120, v112
    v_cvt_pk_bf16_f32 v129, v104, v96
    v_cvt_pk_bf16_f32 v130, v88, v80
    v_cvt_pk_bf16_f32 v131, v72, v64
    ds_write_b128 v6, v[128:131] offset:0
    v_cvt_pk_bf16_f32 v132, v121, v113
    v_cvt_pk_bf16_f32 v133, v105, v97
    v_cvt_pk_bf16_f32 v134, v89, v81
    v_cvt_pk_bf16_f32 v135, v73, v65
    ds_write_b128 v6, v[132:135] offset:128
    v_cvt_pk_bf16_f32 v136, v122, v114
    v_cvt_pk_bf16_f32 v137, v106, v98
    v_cvt_pk_bf16_f32 v138, v90, v82
    v_cvt_pk_bf16_f32 v139, v74, v66
    ds_write_b128 v6, v[136:139] offset:256
    v_cvt_pk_bf16_f32 v140, v123, v115
    v_cvt_pk_bf16_f32 v141, v107, v99
    v_cvt_pk_bf16_f32 v142, v91, v83
    v_cvt_pk_bf16_f32 v143, v75, v67
    ds_write_b128 v6, v[140:143] offset:384
    v_cvt_pk_bf16_f32 v144, v124, v116
    v_cvt_pk_bf16_f32 v145, v108, v100
    v_cvt_pk_bf16_f32 v146, v92, v84
    v_cvt_pk_bf16_f32 v147, v76, v68
    ds_write_b128 v6, v[144:147] offset:512
    v_cvt_pk_bf16_f32 v148, v125, v117
    v_cvt_pk_bf16_f32 v149, v109, v101
    v_cvt_pk_bf16_f32 v150, v93, v85
    v_cvt_pk_bf16_f32 v151, v77, v69
    ds_write_b128 v6, v[148:151] offset:640
    v_cvt_pk_bf16_f32 v152, v126, v118
    v_cvt_pk_bf16_f32 v153, v110, v102
    v_cvt_pk_bf16_f32 v154, v94, v86
    v_cvt_pk_bf16_f32 v155, v78, v70
    ds_write_b128 v6, v[152:155] offset:768
    v_cvt_pk_bf16_f32 v156, v127, v119
    v_cvt_pk_bf16_f32 v157, v111, v103
    v_cvt_pk_bf16_f32 v158, v95, v87
    v_cvt_pk_bf16_f32 v159, v79, v71
    ds_write_b128 v6, v[156:159] offset:896
    s_waitcnt lgkmcnt(0)
    s_barrier
    v_xor_b32 v8, 0, v7
    ds_read_b128 v[160:163], v8 offset:0
    v_xor_b32 v8, 16, v7
    ds_read_b128 v[164:167], v8 offset:1024
    v_xor_b32 v8, 32, v7
    ds_read_b128 v[168:171], v8 offset:2048
    v_xor_b32 v8, 48, v7
    ds_read_b128 v[172:175], v8 offset:3072
    v_xor_b32 v8, 64, v7
    ds_read_b128 v[176:179], v8 offset:4096
    v_xor_b32 v8, 80, v7
    ds_read_b128 v[180:183], v8 offset:5120
    v_xor_b32 v8, 96, v7
    ds_read_b128 v[184:187], v8 offset:6144
    v_xor_b32 v8, 112, v7
    ds_read_b128 v[188:191], v8 offset:7168
    v_lshlrev_b32 v8, 4, v2
    s_lshl_b32 s69, s3, 13
    s_mul_i32 s70, s8, 66304
    s_add_u32 s69, s69, s70
    s_add_u32 s69, s69, 14680064
    s_lshl_b32 s13, s3, 5
    s_add_u32 s13, s13, s8
    s_lshl_b32 s42, s13, 7
    s_add_u32 s42, s42, 13762560
    s_waitcnt lgkmcnt(7)
    buffer_store_dwordx4 v[160:163], v8, s[44:47], s69 offen sc1
    s_add_u32 s69, s69, 1024
    s_waitcnt lgkmcnt(6)
    buffer_store_dwordx4 v[164:167], v8, s[44:47], s69 offen sc1
    s_add_u32 s69, s69, 1024
    s_waitcnt lgkmcnt(5)
    buffer_store_dwordx4 v[168:171], v8, s[44:47], s69 offen sc1
    s_add_u32 s69, s69, 1024
    s_waitcnt lgkmcnt(4)
    buffer_store_dwordx4 v[172:175], v8, s[44:47], s69 offen sc1
    s_add_u32 s69, s69, 1024
    s_waitcnt lgkmcnt(3)
    buffer_store_dwordx4 v[176:179], v8, s[44:47], s69 offen sc1
    s_add_u32 s69, s69, 1024
    s_waitcnt lgkmcnt(2)
    buffer_store_dwordx4 v[180:183], v8, s[44:47], s69 offen sc1
    s_add_u32 s69, s69, 1024
    s_waitcnt lgkmcnt(1)
    buffer_store_dwordx4 v[184:187], v8, s[44:47], s69 offen sc1
    s_add_u32 s69, s69, 1024
    s_waitcnt lgkmcnt(0)
    buffer_store_dwordx4 v[188:191], v8, s[44:47], s69 offen sc1
    s_add_u32 s69, s69, 1024
    v_mov_b32 v14, 0
    v_mov_b32 v15, 0
    s_mov_b32 s12, 0x3f803f80
    s_waitcnt vmcnt(0)
    v_dot2_f32_bf16 v14, v192, s12, v14
    v_dot2_f32_bf16 v15, v192, v192, v15
    v_dot2_f32_bf16 v14, v193, s12, v14
    v_dot2_f32_bf16 v15, v193, v193, v15
    v_dot2_f32_bf16 v14, v194, s12, v14
    v_dot2_f32_bf16 v15, v194, v194, v15
    v_dot2_f32_bf16 v14, v195, s12, v14
    v_dot2_f32_bf16 v15, v195, v195, v15
    v_dot2_f32_bf16 v14, v196, s12, v14
    v_dot2_f32_bf16 v15, v196, v196, v15
    v_dot2_f32_bf16 v14, v197, s12, v14
    v_dot2_f32_bf16 v15, v197, v197, v15
    v_dot2_f32_bf16 v14, v198, s12, v14
    v_dot2_f32_bf16 v15, v198, v198, v15
    v_dot2_f32_bf16 v14, v199, s12, v14
    v_dot2_f32_bf16 v15, v199, v199, v15
    v_dot2_f32_bf16 v14, v200, s12, v14
    v_dot2_f32_bf16 v15, v200, v200, v15
    v_dot2_f32_bf16 v14, v201, s12, v14
    v_dot2_f32_bf16 v15, v201, v201, v15
    v_dot2_f32_bf16 v14, v202, s12, v14
    v_dot2_f32_bf16 v15, v202, v202, v15
    v_dot2_f32_bf16 v14, v203, s12, v14
    v_dot2_f32_bf16 v15, v203, v203, v15
    v_dot2_f32_bf16 v14, v204, s12, v14
    v_dot2_f32_bf16 v15, v204, v204, v15
    v_dot2_f32_bf16 v14, v205, s12, v14
    v_dot2_f32_bf16 v15, v205, v205, v15
    v_dot2_f32_bf16 v14, v206, s12, v14
    v_dot2_f32_bf16 v15, v206, v206, v15
    v_dot2_f32_bf16 v14, v207, s12, v14
    v_dot2_f32_bf16 v15, v207, v207, v15
    v_dot2_f32_bf16 v14, v208, s12, v14
    v_dot2_f32_bf16 v15, v208, v208, v15
    v_dot2_f32_bf16 v14, v209, s12, v14
    v_dot2_f32_bf16 v15, v209, v209, v15
    v_dot2_f32_bf16 v14, v210, s12, v14
    v_dot2_f32_bf16 v15, v210, v210, v15
    v_dot2_f32_bf16 v14, v211, s12, v14
    v_dot2_f32_bf16 v15, v211, v211, v15
    v_dot2_f32_bf16 v14, v212, s12, v14
    v_dot2_f32_bf16 v15, v212, v212, v15
    v_dot2_f32_bf16 v14, v213, s12, v14
    v_dot2_f32_bf16 v15, v213, v213, v15
    v_dot2_f32_bf16 v14, v214, s12, v14
    v_dot2_f32_bf16 v15, v214, v214, v15
    v_dot2_f32_bf16 v14, v215, s12, v14
    v_dot2_f32_bf16 v15, v215, v215, v15
    v_dot2_f32_bf16 v14, v216, s12, v14
    v_dot2_f32_bf16 v15, v216, v216, v15
    v_dot2_f32_bf16 v14, v217, s12, v14
    v_dot2_f32_bf16 v15, v217, v217, v15
    v_dot2_f32_bf16 v14, v218, s12, v14
    v_dot2_f32_bf16 v15, v218, v218, v15
    v_dot2_f32_bf16 v14, v219, s12, v14
    v_dot2_f32_bf16 v15, v219, v219, v15
    v_dot2_f32_bf16 v14, v220, s12, v14
    v_dot2_f32_bf16 v15, v220, v220, v15
    v_dot2_f32_bf16 v14, v221, s12, v14
    v_dot2_f32_bf16 v15, v221, v221, v15
    v_dot2_f32_bf16 v14, v222, s12, v14
    v_dot2_f32_bf16 v15, v222, v222, v15
    v_dot2_f32_bf16 v14, v223, s12, v14
    v_dot2_f32_bf16 v15, v223, v223, v15
    s_nop 1
    v_add_f32_dpp v14, v14, v14 quad_perm:[1,0,3,2] row_mask:0xf bank_mask:0xf
    v_add_f32_dpp v15, v15, v15 quad_perm:[1,0,3,2] row_mask:0xf bank_mask:0xf
    s_nop 1
    v_add_f32_dpp v14, v14, v14 quad_perm:[2,3,0,1] row_mask:0xf bank_mask:0xf
    v_add_f32_dpp v15, v15, v15 quad_perm:[2,3,0,1] row_mask:0xf bank_mask:0xf
    s_nop 1
    v_add_f32_dpp v14, v14, v14 row_half_mirror row_mask:0xf bank_mask:0xf
    v_add_f32_dpp v15, v15, v15 row_half_mirror row_mask:0xf bank_mask:0xf
    v_mul_f32 v14, 989855744, v14
    v_mul_f32 v15, 989855744, v15
    v_fma_f32 v15, -v14, v14, v15
    v_max_f32 v15, 0, v15
    v_cvt_pk_bf16_f32 v28, v14, v15
    v_lshlrev_b32 v14, 16, v28
    v_and_b32 v15, 0xffff0000, v28
    v_add_f32 v15, 925353388, v15
    v_cvt_pk_bf16_f32 v15, v15, v15
    v_and_b32 v15, 0xffff0000, v15
    v_sqrt_f32 v15, v15
    s_nop 0
    v_cvt_pk_bf16_f32 v15, v15, v15
    v_and_b32 v15, 0xffff0000, v15
    v_rcp_f32 v15, v15
    s_nop 0
    s_lshl_b32 s13, s9, 3
    s_add_u32 s13, s13, s3
    s_lshl_b32 s13, s13, 6
    s_add_u32 s13, s13, 12582912
    v_lshlrev_b32 v16, 3, v4
    buffer_store_dwordx2 v[14:15], v16, s[44:47], s13 offen sc1
    s_mov_b32 s68, 200000
tag_9:
    v_readfirstlane_b32 s6, v30
    v_readfirstlane_b32 s7, v31
    s_cmp_lg_u32 s7, 0
    s_cbranch_scc1 tagd_10
    s_sleep 2
    buffer_load_dwordx2 v[30:31], off, s[64:67], 0 sc1
    s_sub_u32 s68, s68, 1
    s_cmp_lg_u32 s68, 0
    s_waitcnt vmcnt(0)
    s_cbranch_scc1 tag_9
tagd_10:
    s_waitcnt vmcnt(0)
    s_barrier
    v_mov_b32 v28, s6
    v_mov_b32 v29, s7
    s_mov_b64 exec, 1
    buffer_store_dwordx2 v[28:29], off, s[44:47], s42 sc1
    s_mov_b64 exec, -1
    s_cmp_lt_u32 s3, 4
    s_cbranch_scc1 L_g2
    s_mov_b32 s56, s24
    s_and_b32 s57, s25, 0xffff
    s_mov_b32 s58, 2097152
    s_mov_b32 s59, 0x20000
    s_mov_b32 s60, s26
    s_and_b32 s61, s27, 0xffff
    s_mov_b32 s62, 1024
    s_mov_b32 s63, 0x20000
    s_lshl_b32 s43, s4, 5
    s_add_u32 s43, s43, s5
    s_lshl_b32 s43, s43, 1
    s_bfe_u32 s68, s3, 0x10001
    s_add_u32 s43, s43, s68
    s_and_b32 s90, s3, 1
    s_lshl_b32 s68, s43, 12
    s_lshl_b32 s69, s90, 11
    s_add_u32 s68, s68, s69
    s_lshl_b32 s69, s43, 1
    v_lshlrev_b32 v9, 4, v2
    buffer_load_dwordx4 v[64:67], v9, s[56:59], s68 offen offset:0
    buffer_load_dwordx4 v[68:71], v9, s[56:59], s68 offen offset:4
    buffer_load_dwordx4 v[72:75], v9, s[56:59], s68 offen offset:8
    buffer_load_dwordx4 v[76:79], v9, s[56:59], s68 offen offset:1024
    buffer_load_dwordx4 v[80:83], v9, s[56:59], s68 offen offset:1028
    buffer_load_dwordx4 v[84:87], v9, s[56:59], s68 offen offset:1032
    buffer_load_ushort v112, off, s[60:63], s69
    s_mov_b32 s92, s34
    s_and_b32 s93, s35, 0xffff
    s_mov_b32 s94, 1835008
    s_mov_b32 s95, 0x20000
    v_lshrrev_b32 v24, 3, v2
    v_bfe_u32 v25, v2, 1, 2
    v_xor_b32 v25, v25, v1
    v_lshlrev_b32 v24, 10, v24
    v_lshl_add_u32 v24, v25, 5, v24
    v_and_b32 v25, 1, v2
    v_lshl_add_u32 v24, v25, 4, v24
    s_and_b32 s83, s3, 3
    s_mul_i32 s82, s83, 458752
    s_lshl_b32 s68, s77, 7
    s_add_u32 s82, s82, s68
    s_lshl_b32 s83, s83, 12
    s_add_u32 m0, s83, 65536
    s_add_u32 s68, s82, 0
    buffer_load_dwordx4 v24, s[92:95], s68 offen  lds
    s_add_u32 m0, s83, 66560
    s_add_u32 s68, s82, 8192
    buffer_load_dwordx4 v24, s[92:95], s68 offen  lds
    s_add_u32 m0, s83, 67584
    s_add_u32 s68, s82, 16384
    buffer_load_dwordx4 v24, s[92:95], s68 offen  lds
    s_add_u32 m0, s83, 68608
    s_add_u32 s68, s82, 24576
    buffer_load_dwordx4 v24, s[92:95], s68 offen  lds
    s_add_u32 m0, s83, 81920
    s_add_u32 s68, s82, 32768
    buffer_load_dwordx4 v24, s[92:95], s68 offen  lds
    s_add_u32 m0, s83, 82944
    s_add_u32 s68, s82, 40960
    buffer_load_dwordx4 v24, s[92:95], s68 offen  lds
    s_add_u32 m0, s83, 83968
    s_add_u32 s68, s82, 49152
    buffer_load_dwordx4 v24, s[92:95], s68 offen  lds
    s_add_u32 m0, s83, 84992
    s_add_u32 s68, s82, 57344
    buffer_load_dwordx4 v24, s[92:95], s68 offen  lds
    s_add_u32 m0, s83, 0
    s_add_u32 s68, s82, 65536
    buffer_load_dwordx4 v24, s[92:95], s68 offen  lds
    s_add_u32 m0, s83, 1024
    s_add_u32 s68, s82, 73728
    buffer_load_dwordx4 v24, s[92:95], s68 offen  lds
    s_add_u32 m0, s83, 2048
    s_add_u32 s68, s82, 81920
    buffer_load_dwordx4 v24, s[92:95], s68 offen  lds
    s_add_u32 m0, s83, 3072
    s_add_u32 s68, s82, 90112
    buffer_load_dwordx4 v24, s[92:95], s68 offen  lds
    s_add_u32 m0, s83, 16384
    s_add_u32 s68, s82, 98304
    buffer_load_dwordx4 v24, s[92:95], s68 offen  lds
    s_add_u32 m0, s83, 17408
    s_add_u32 s68, s82, 106496
    buffer_load_dwordx4 v24, s[92:95], s68 offen  lds
    s_add_u32 m0, s83, 18432
    s_add_u32 s68, s82, 114688
    buffer_load_dwordx4 v24, s[92:95], s68 offen  lds
    s_add_u32 m0, s83, 19456
    s_add_u32 s68, s82, 122880
    buffer_load_dwordx4 v24, s[92:95], s68 offen  lds
    s_add_u32 m0, s83, 32768
    s_add_u32 s68, s82, 131072
    buffer_load_dwordx4 v24, s[92:95], s68 offen  lds
    s_add_u32 m0, s83, 33792
    s_add_u32 s68, s82, 139264
    buffer_load_dwordx4 v24, s[92:95], s68 offen  lds
    s_add_u32 m0, s83, 34816
    s_add_u32 s68, s82, 147456
    buffer_load_dwordx4 v24, s[92:95], s68 offen  lds
    s_add_u32 m0, s83, 35840
    s_add_u32 s68, s82, 155648
    buffer_load_dwordx4 v24, s[92:95], s68 offen  lds
    s_add_u32 m0, s83, 49152
    s_add_u32 s68, s82, 163840
    buffer_load_dwordx4 v24, s[92:95], s68 offen  lds
    s_add_u32 m0, s83, 50176
    s_add_u32 s68, s82, 172032
    buffer_load_dwordx4 v24, s[92:95], s68 offen  lds
    s_add_u32 m0, s83, 51200
    s_add_u32 s68, s82, 180224
    buffer_load_dwordx4 v24, s[92:95], s68 offen  lds
    s_add_u32 m0, s83, 52224
    s_add_u32 s68, s82, 188416
    buffer_load_dwordx4 v24, s[92:95], s68 offen  lds
    v_min_u32 v8, 31, v2
    v_lshlrev_b32 v8, 7, v8
    s_lshl_b32 s42, s4, 12
    s_add_u32 s42, s42, 13762560
    buffer_load_dwordx2 v[30:31], v8, s[44:47], s42 offen sc1
    s_waitcnt vmcnt(0)
    s_mov_b32 s68, 200000
pl_11:
    v_cmp_ne_u64 vcc, s[6:7], v[30:31]
    s_cbranch_vccz pld_12
    s_sleep 4
    buffer_load_dwordx2 v[30:31], v8, s[44:47], s42 offen sc1
    s_sub_u32 s68, s68, 1
    s_cmp_lg_u32 s68, 0
    s_waitcnt vmcnt(0)
    s_cbranch_scc1 pl_11
pld_12:
    s_lshl_b32 s68, s43, 7
    s_mul_i32 s69, s90, 1060864
    s_add_u32 s68, s68, s69
    s_add_u32 s68, s68, 14680064
    s_add_u32 s69, s68, 530432
    v_lshrrev_b32 v8, 3, v2
    v_mul_u32_u24 v8, 66304, v8
    v_and_b32 v9, 7, v2
    v_lshl_add_u32 v8, v9, 4, v8
    buffer_load_dwordx4 v[114:117], v8, s[44:47], s68 offen sc1
    buffer_load_dwordx4 v[118:121], v8, s[44:47], s69 offen sc1
    v_lshlrev_b32 v8, 3, v2
    s_lshl_b32 s68, s76, 9
    s_add_u32 s68, s68, 12582912
    buffer_load_dwordx2 v[122:123], v8, s[44:47], s68 offen sc1
    s_waitcnt vmcnt(0)
    s_branch L_ph2aux
L_end:
    s_endpgm
.section .rodata,"a"
.p2align 6
.amdhsa_kernel parallel_sum__ssm_conv_h3__geglu_ffn__prompt_kernel
  .amdhsa_next_free_vgpr 256
  .amdhsa_next_free_sgpr 102
  .amdhsa_accum_offset 256
  .amdhsa_group_segment_fixed_size 0
  .amdhsa_kernarg_size 104
  .amdhsa_user_sgpr_count 2
  .amdhsa_user_sgpr_kernarg_segment_ptr 1
  .amdhsa_system_sgpr_workgroup_id_x 1
.end_amdhsa_kernel
```
